```python
import torch

def _softmax(x, axis=-1):
    return torch.softmax(x, dim=axis)
def _gelu(x):
    return torch.nn.functional.gelu(x, approximate="tanh")
def _silu(x):
    return torch.nn.functional.silu(x)
def _sigmoid(x):
    return torch.sigmoid(x)
def _layernorm(x, axis=-1, eps=1e-5):
    m = x.mean(dim=axis, keepdim=True)
    v = x.var(dim=axis, keepdim=True, unbiased=False)
    return (x - m) / torch.sqrt(v + eps)
def _scatter_add(tgt, idx, src, axis=0):
    return tgt.clone().index_add_(axis, idx, src)
def _segment_sum(src, seg, n):
    out = torch.zeros((n,) + src.shape[1:], dtype=src.dtype)
    return out.index_add_(0, seg, src)
def _pad(x, pw):
    flat = tuple(v for pair in reversed(pw) for v in pair)
    return torch.nn.functional.pad(x, flat)

kernel_name = 'standalone__low_rank_proj_linformer__sampling'

def setup_inputs():

    _w = (lambda a: (lambda t: t.to(torch.bfloat16) if t.is_floating_point() else t)(torch.as_tensor(a)))
    B, H, Sq, Skv, Dh, R = 8, 32, 4, 2048, 128, 64
    return {
        "q": _w((lambda *s: torch.randn(*s, dtype=torch.bfloat16) * 0.8)(B, H, Sq, Dh)),
        "k": _w((lambda *s: torch.randn(*s, dtype=torch.bfloat16) * 0.8)(B, H, Skv, Dh)),
        "v": _w((lambda *s: torch.randn(*s, dtype=torch.bfloat16) * 0.05)(B, H, Skv, Dh)),
        "e_proj": _w((lambda *s: torch.randn(*s, dtype=torch.bfloat16) * 0.8)(R, Skv) * (Skv ** -0.5)),
        "f_proj": _w((lambda *s: torch.randn(*s, dtype=torch.bfloat16) * 0.05)(R, Skv) * (Skv ** -0.5)),
    }

def reference(q, k, v, e_proj, f_proj):
    B, H, Sq, Dh = q.shape
    kp = torch.einsum("rn,bhnd->bhrd", e_proj, k)
    vp = torch.einsum("rn,bhnd->bhrd", f_proj, v)
    scores = torch.einsum("bhqd,bhrd->bhqr", q, kp) * (Dh ** -0.5)
    p = _softmax(scores, axis=-1)
    o = torch.einsum("bhqr,bhrd->bhqd", p, vp)
    return o
```

```asm
; @launch grid=(256,1,1) block=(320,1,1) lds=152576
.amdgcn_target "amdgcn-amd-amdhsa--gfx950"
.text
.globl standalone__low_rank_proj_linformer__sampling_kernel
.p2align 8
.type standalone__low_rank_proj_linformer__sampling_kernel,@function
standalone__low_rank_proj_linformer__sampling_kernel:
    s_cmp_ge_u32 s2, 256
    s_cbranch_scc1 L_done
    s_load_dwordx16 s[4:19], s[0:1], 0
    s_mov_b32 s55, s2
    v_lshrrev_b32 v24, 6, v0
    v_and_b32 v0, 63, v0
    v_lshrrev_b32 v25, 4, v0
    v_readfirstlane_b32 s20, v24
    v_and_b32 v26, 15, v0
    v_xor_b32 v27, v26, v25
    v_lshlrev_b32 v28, 8, v25
    s_cmp_lg_u32 s20, 0
    s_cbranch_scc1 L_cons
    v_lshl_add_u32 v1, v27, 4, v28
    v_xor_b32 v2, 64, v1
    v_xor_b32 v3, 128, v1
    v_xor_b32 v4, 192, v1
    s_lshr_b32 s22, s55, 4
    s_and_b32 s22, s22, 15
    s_mul_i32 s22, s22, 2
    s_and_b32 s22, s22, 31
    s_lshl_b32 s23, s22, 7
    s_lshl_b32 s22, s22, 14
    s_lshl_b32 s48, s2, 19
    s_lshr_b32 s49, s2, 13
    s_mov_b32 s26, 0x80000
    s_mov_b32 s27, 0x20000
    s_mov_b32 s30, 0x40000
    s_mov_b32 s31, 0x20000
    s_mov_b32 s34, 1024
    s_mov_b32 s35, 0x20000
    s_lshl_b32 s50, s2, 10
    v_lshrrev_b32 v29, 3, v0
    v_and_b32 v30, 7, v0
    v_xor_b32 v31, v30, v25
    v_lshlrev_b32 v32, 12, v29
    v_lshl_add_u32 v8, v31, 4, v32
    v_xor_b32 v31, 64, v8
    v_add_u32 v9, 31744, v31
    v_add_u32 v10, 65536, v8
    v_add_u32 v11, 97280, v31
    v_add_u32 v12, 131072, v8
    v_add_u32 v13, 162816, v31
    v_add_u32 v14, 196608, v8
    v_add_u32 v15, 228352, v31
    v_lshlrev_b32 v24, 4, v0
    s_waitcnt lgkmcnt(0)
    s_add_u32 s24, s6, s48
    s_addc_u32 s25, s7, s49
    s_mov_b32 s28, s10
    s_mov_b32 s29, s11
    s_mov_b32 s40, 0
    s_add_u32 m0, s40, 0
    s_nop 0
    buffer_load_dwordx4 v1, s[24:27], s22 offen offset:0 nt lds
    buffer_load_dwordx4 v2, s[24:27], s22 offen offset:1024 nt lds
    buffer_load_dwordx4 v3, s[24:27], s22 offen offset:2048 nt lds
    buffer_load_dwordx4 v4, s[24:27], s22 offen offset:3072 nt lds
    s_add_u32 s22, s22, 4096
    s_mov_b32 s40, 122880
    s_add_u32 m0, s40, 16384
    s_nop 0
    buffer_load_dwordx4 v8, s[28:31], s23 offen offset:0  lds
    buffer_load_dwordx4 v9, s[28:31], s23 offen offset:1024  lds
    s_mov_b32 s40, 0
    s_add_u32 m0, s40, 4096
    s_nop 0
    buffer_load_dwordx4 v1, s[24:27], s22 offen offset:0 nt lds
    buffer_load_dwordx4 v2, s[24:27], s22 offen offset:1024 nt lds
    buffer_load_dwordx4 v3, s[24:27], s22 offen offset:2048 nt lds
    buffer_load_dwordx4 v4, s[24:27], s22 offen offset:3072 nt lds
    s_add_u32 s22, s22, 4096
    s_mov_b32 s40, 122880
    s_add_u32 m0, s40, 18432
    s_nop 0
    buffer_load_dwordx4 v10, s[28:31], s23 offen offset:0  lds
    buffer_load_dwordx4 v11, s[28:31], s23 offen offset:1024  lds
    s_mov_b32 s40, 0
    s_add_u32 m0, s40, 8192
    s_nop 0
    buffer_load_dwordx4 v1, s[24:27], s22 offen offset:0 nt lds
    buffer_load_dwordx4 v2, s[24:27], s22 offen offset:1024 nt lds
    buffer_load_dwordx4 v3, s[24:27], s22 offen offset:2048 nt lds
    buffer_load_dwordx4 v4, s[24:27], s22 offen offset:3072 nt lds
    s_add_u32 s22, s22, 4096
    s_mov_b32 s40, 122880
    s_add_u32 m0, s40, 20480
    s_nop 0
    buffer_load_dwordx4 v12, s[28:31], s23 offen offset:0  lds
    buffer_load_dwordx4 v13, s[28:31], s23 offen offset:1024  lds
    s_mov_b32 s40, 0
    s_add_u32 m0, s40, 12288
    s_nop 0
    buffer_load_dwordx4 v1, s[24:27], s22 offen offset:0 nt lds
    buffer_load_dwordx4 v2, s[24:27], s22 offen offset:1024 nt lds
    buffer_load_dwordx4 v3, s[24:27], s22 offen offset:2048 nt lds
    buffer_load_dwordx4 v4, s[24:27], s22 offen offset:3072 nt lds
    s_add_u32 s22, s22, 4096
    s_mov_b32 s40, 122880
    s_add_u32 m0, s40, 22528
    s_nop 0
    buffer_load_dwordx4 v14, s[28:31], s23 offen offset:0  lds
    buffer_load_dwordx4 v15, s[28:31], s23 offen offset:1024  lds
    s_add_u32 s23, s23, 128
    s_and_b32 s23, s23, 0xfff
    s_and_b32 s22, s22, 0x7ffff
    s_add_u32 s32, s4, s50
    s_addc_u32 s33, s5, 0
    s_mov_b32 m0, 151552
    s_mov_b32 s40, 0
    buffer_load_dwordx4 v24, s[32:35], 0 offen lds
    s_add_u32 m0, s40, 16384
    s_nop 0
    buffer_load_dwordx4 v8, s[28:31], s23 offen offset:0  lds
    buffer_load_dwordx4 v9, s[28:31], s23 offen offset:1024  lds
    s_add_u32 m0, s40, 18432
    s_nop 0
    buffer_load_dwordx4 v10, s[28:31], s23 offen offset:0  lds
    buffer_load_dwordx4 v11, s[28:31], s23 offen offset:1024  lds
    s_add_u32 m0, s40, 20480
    s_nop 0
    buffer_load_dwordx4 v12, s[28:31], s23 offen offset:0  lds
    buffer_load_dwordx4 v13, s[28:31], s23 offen offset:1024  lds
    s_add_u32 m0, s40, 22528
    s_nop 0
    buffer_load_dwordx4 v14, s[28:31], s23 offen offset:0  lds
    buffer_load_dwordx4 v15, s[28:31], s23 offen offset:1024  lds
    s_add_u32 s23, s23, 128
    s_and_b32 s23, s23, 0xfff
    v_lshlrev_b32 v31, 1, v25
    v_xor_b32 v31, v31, v26
    v_lshl_add_u32 v5, v31, 4, v28
    v_xor_b32 v6, 0x80, v5
    v_and_b32 v31, 6, v29
    v_xor_b32 v31, v31, v30
    v_lshl_add_u32 v16, v31, 4, v32
    v_add_u32 v17, 31744, v16
    v_add_u32 v18, 65536, v16
    v_add_u32 v19, 97280, v16
    v_add_u32 v20, 131072, v16
    v_add_u32 v21, 162816, v16
    v_add_u32 v22, 196608, v16
    v_add_u32 v23, 228352, v16
    s_mov_b32 s3, 1
L_ld:
    s_add_u32 s40, s40, 24576
    s_cmp_eq_u32 s40, 147456
    s_cselect_b32 s40, 0, s40
    s_cmp_lg_u32 s3, 31
    s_cbranch_scc1 L_ld1
    s_mov_b32 s28, s12
    s_mov_b32 s29, s13
    v_mov_b32 v8, v16
    v_mov_b32 v9, v17
    v_mov_b32 v10, v18
    v_mov_b32 v11, v19
    v_mov_b32 v12, v20
    v_mov_b32 v13, v21
    v_mov_b32 v14, v22
    v_mov_b32 v15, v23
L_ld1:
    s_cmp_lg_u32 s3, 32
    s_cbranch_scc1 L_ld2
    s_add_u32 s24, s8, s48
    s_addc_u32 s25, s9, s49
    v_mov_b32 v1, v5
    v_mov_b32 v2, v6
    v_mov_b32 v3, v5
    v_mov_b32 v4, v6
L_ld2:
    s_cmp_eq_u32 s3, 63
    s_cbranch_scc1 L_ldlast
    s_waitcnt vmcnt(32)
    s_add_u32 m0, s40, 16384
    s_nop 0
    buffer_load_dwordx4 v8, s[28:31], s23 offen offset:0  lds
    buffer_load_dwordx4 v9, s[28:31], s23 offen offset:1024  lds
    s_add_u32 m0, s40, 0
    s_nop 0
    buffer_load_dwordx4 v1, s[24:27], s22 offen offset:0 nt lds
    buffer_load_dwordx4 v2, s[24:27], s22 offen offset:1024 nt lds
    buffer_load_dwordx4 v3, s[24:27], s22 offen offset:2048 nt lds
    buffer_load_dwordx4 v4, s[24:27], s22 offen offset:3072 nt lds
    s_add_u32 s22, s22, 4096
    s_waitcnt vmcnt(32)
    s_add_u32 m0, s40, 18432
    s_nop 0
    buffer_load_dwordx4 v10, s[28:31], s23 offen offset:0  lds
    buffer_load_dwordx4 v11, s[28:31], s23 offen offset:1024  lds
    s_add_u32 m0, s40, 4096
    s_nop 0
    buffer_load_dwordx4 v1, s[24:27], s22 offen offset:0 nt lds
    buffer_load_dwordx4 v2, s[24:27], s22 offen offset:1024 nt lds
    buffer_load_dwordx4 v3, s[24:27], s22 offen offset:2048 nt lds
    buffer_load_dwordx4 v4, s[24:27], s22 offen offset:3072 nt lds
    s_add_u32 s22, s22, 4096
    s_waitcnt vmcnt(32)
    s_add_u32 m0, s40, 20480
    s_nop 0
    buffer_load_dwordx4 v12, s[28:31], s23 offen offset:0  lds
    buffer_load_dwordx4 v13, s[28:31], s23 offen offset:1024  lds
    s_add_u32 m0, s40, 8192
    s_nop 0
    buffer_load_dwordx4 v1, s[24:27], s22 offen offset:0 nt lds
    buffer_load_dwordx4 v2, s[24:27], s22 offen offset:1024 nt lds
    buffer_load_dwordx4 v3, s[24:27], s22 offen offset:2048 nt lds
    buffer_load_dwordx4 v4, s[24:27], s22 offen offset:3072 nt lds
    s_add_u32 s22, s22, 4096
    s_waitcnt vmcnt(32)
    s_add_u32 m0, s40, 22528
    s_nop 0
    buffer_load_dwordx4 v14, s[28:31], s23 offen offset:0  lds
    buffer_load_dwordx4 v15, s[28:31], s23 offen offset:1024  lds
    s_add_u32 m0, s40, 12288
    s_nop 0
    buffer_load_dwordx4 v1, s[24:27], s22 offen offset:0 nt lds
    buffer_load_dwordx4 v2, s[24:27], s22 offen offset:1024 nt lds
    buffer_load_dwordx4 v3, s[24:27], s22 offen offset:2048 nt lds
    buffer_load_dwordx4 v4, s[24:27], s22 offen offset:3072 nt lds
    s_add_u32 s22, s22, 4096
    s_add_u32 s23, s23, 128
    s_and_b32 s23, s23, 0xfff
    s_and_b32 s22, s22, 0x7ffff
    s_add_u32 s3, s3, 1
    s_cmp_le_u32 s3, 2
    s_cbranch_scc1 L_ld
    s_waitcnt vmcnt(48)
    s_barrier
    s_branch L_ld
L_ldlast:
    s_add_u32 m0, s40, 0
    s_nop 0
    buffer_load_dwordx4 v1, s[24:27], s22 offen offset:0 nt lds
    buffer_load_dwordx4 v2, s[24:27], s22 offen offset:1024 nt lds
    buffer_load_dwordx4 v3, s[24:27], s22 offen offset:2048 nt lds
    buffer_load_dwordx4 v4, s[24:27], s22 offen offset:3072 nt lds
    s_add_u32 s22, s22, 4096
    s_add_u32 m0, s40, 4096
    s_nop 0
    buffer_load_dwordx4 v1, s[24:27], s22 offen offset:0 nt lds
    buffer_load_dwordx4 v2, s[24:27], s22 offen offset:1024 nt lds
    buffer_load_dwordx4 v3, s[24:27], s22 offen offset:2048 nt lds
    buffer_load_dwordx4 v4, s[24:27], s22 offen offset:3072 nt lds
    s_add_u32 s22, s22, 4096
    s_add_u32 m0, s40, 8192
    s_nop 0
    buffer_load_dwordx4 v1, s[24:27], s22 offen offset:0 nt lds
    buffer_load_dwordx4 v2, s[24:27], s22 offen offset:1024 nt lds
    buffer_load_dwordx4 v3, s[24:27], s22 offen offset:2048 nt lds
    buffer_load_dwordx4 v4, s[24:27], s22 offen offset:3072 nt lds
    s_add_u32 s22, s22, 4096
    s_add_u32 m0, s40, 12288
    s_nop 0
    buffer_load_dwordx4 v1, s[24:27], s22 offen offset:0 nt lds
    buffer_load_dwordx4 v2, s[24:27], s22 offen offset:1024 nt lds
    buffer_load_dwordx4 v3, s[24:27], s22 offen offset:2048 nt lds
    buffer_load_dwordx4 v4, s[24:27], s22 offen offset:3072 nt lds
    s_add_u32 s22, s22, 4096
    s_waitcnt vmcnt(40)
    s_barrier
    s_waitcnt vmcnt(16)
    s_barrier
    s_waitcnt vmcnt(8)
    s_barrier
    s_waitcnt vmcnt(0)
    s_barrier
    s_endpgm
L_cons:
    s_sub_u32 s21, s20, 1
    v_mov_b32 v16, v25
    v_mov_b32 v17, v26
    v_mov_b32 v18, v27
    s_lshl_b32 s50, s21, 12
    v_lshlrev_b32 v19, 8, v17
    v_lshl_add_u32 v15, v16, 4, v19
    v_and_b32 v15, 0x3ff, v15
    v_add_u32 v56, 151552, v15
    v_lshl_add_u32 v19, v18, 4, v19
    v_add_u32 v1, s50, v19
    v_xor_b32 v2, 64, v1
    v_xor_b32 v3, 128, v1
    v_xor_b32 v4, 192, v1
    s_lshl_b32 s51, s21, 1
    v_lshrrev_b32 v19, 1, v16
    v_or_b32 v19, s51, v19
    v_lshrrev_b32 v20, 1, v17
    v_xor_b32 v19, v19, v20
    v_lshlrev_b32 v20, 7, v17
    v_lshl_add_u32 v19, v19, 4, v20
    v_and_b32 v20, 1, v16
    v_lshl_add_u32 v19, v20, 3, v19
    v_add_u32 v7, 139264, v19
    v_lshrrev_b32 v20, 2, v0
    v_bfe_u32 v21, v0, 1, 1
    v_and_b32 v22, 1, v0
    v_and_b32 v15, 6, v20
    v_or_b32 v19, v15, v21
    v_lshlrev_b32 v15, 7, v20
    v_lshl_add_u32 v19, v19, 4, v15
    v_lshl_add_u32 v19, v22, 3, v19
    v_add_u32 v8, 40960, v19
    v_xor_b32 v9, 32, v8
    v_xor_b32 v10, 64, v8
    v_xor_b32 v11, 96, v8
    s_lshl_b32 s50, s21, 6
    v_and_b32 v19, 7, v20
    v_lshl_or_b32 v19, v19, 1, v21
    v_lshlrev_b32 v15, 8, v20
    v_lshl_add_u32 v19, v19, 4, v15
    v_lshl_add_u32 v19, v22, 3, v19
    v_xor_b32 v19, s50, v19
    v_add_u32 v5, 49152, v19
    v_xor_b32 v6, 32, v5
    v_lshlrev_b32 v18, 8, v17
    v_lshl_add_u32 v18, v16, 3, v18
    v_add_u32 v18, s50, v18
    v_and_b32 v21, 3, v0
    v_lshl_add_u32 v22, v16, 2, v21
    v_lshlrev_b32 v22, 4, v22
    s_lshl_b32 s51, s21, 10
    s_add_u32 s51, s51, 147456
    v_add_u32 v15, s51, v22
    v_add_u32 v19, 147456, v22
    v_bfe_i32 v23, v0, 2, 1
    v_lshlrev_b32 v23, 16, v23
    s_mov_b32 s43, 0x07060302
    s_lshl_b32 s50, s2, 10
    s_waitcnt lgkmcnt(0)
    s_add_u32 s36, s14, s50
    s_addc_u32 s37, s15, 0
    s_mov_b32 s38, 1024
    s_mov_b32 s39, 0x20000
    s_mov_b32 s46, 24576
    s_mov_b32 s47, 4294844416
    s_barrier
    ds_read_b128 v[136:139], v56 offset:0
    ds_read_b128 v[140:143], v56 offset:64
    ds_read_b128 v[144:147], v56 offset:128
    ds_read_b128 v[148:151], v56 offset:192
    ds_read_b64 v[24:25], v7 offset:0
    ds_read_b64 v[26:27], v7 offset:2048
    ds_read_b64 v[28:29], v7 offset:4096
    ds_read_b64 v[30:31], v7 offset:6144
    v_add_u32 v7, s47, v7
    s_waitcnt lgkmcnt(0)
    ds_read_b128 v[40:43], v1
    ds_read_b128 v[44:47], v2
    ds_read_b128 v[48:51], v3
    ds_read_b128 v[52:55], v4
    ds_read_b64 v[32:33], v7 offset:0
    ds_read_b64 v[34:35], v7 offset:2048
    ds_read_b64 v[36:37], v7 offset:4096
    ds_read_b64 v[38:39], v7 offset:6144
    s_waitcnt lgkmcnt(7)
    v_mfma_f32_16x16x32_bf16 v[88:91], v[40:43], v[136:139], 0
    s_waitcnt lgkmcnt(6)
    v_mfma_f32_16x16x32_bf16 v[88:91], v[44:47], v[140:143], v[88:91]
    s_waitcnt lgkmcnt(5)
    v_mfma_f32_16x16x32_bf16 v[88:91], v[48:51], v[144:147], v[88:91]
    s_waitcnt lgkmcnt(4)
    v_mfma_f32_16x16x32_bf16 v[88:91], v[52:55], v[148:151], v[88:91]
    v_add_u32 v1, s46, v1
    v_add_u32 v2, s46, v2
    v_add_u32 v3, s46, v3
    v_add_u32 v4, s46, v4
    v_add_u32 v7, s46, v7
    s_nop 2
    v_and_b32 v104, v23, v88
    v_and_b32 v105, v23, v89
    v_and_b32 v106, v23, v90
    v_and_b32 v107, v23, v91
    v_sub_f32 v104, v88, v104
    v_sub_f32 v105, v89, v105
    v_sub_f32 v106, v90, v106
    v_sub_f32 v107, v91, v107
    v_perm_b32 v168, v105, v104, s43
    v_perm_b32 v169, v107, v106, s43
    s_nop 1
    v_mfma_f32_16x16x16_bf16 v[152:155], v[24:25], v[168:169], 0
    v_mfma_f32_16x16x16_bf16 v[156:159], v[26:27], v[168:169], 0
    v_mfma_f32_16x16x16_bf16 v[160:163], v[28:29], v[168:169], 0
    v_mfma_f32_16x16x16_bf16 v[164:167], v[30:31], v[168:169], 0
    s_waitcnt lgkmcnt(0)
    s_barrier
    ds_read_b128 v[40:43], v1
    ds_read_b128 v[44:47], v2
    ds_read_b128 v[48:51], v3
    ds_read_b128 v[52:55], v4
    ds_read_b64 v[24:25], v7 offset:0
    ds_read_b64 v[26:27], v7 offset:2048
    ds_read_b64 v[28:29], v7 offset:4096
    ds_read_b64 v[30:31], v7 offset:6144
    s_waitcnt lgkmcnt(7)
    v_mfma_f32_16x16x32_bf16 v[88:91], v[40:43], v[136:139], 0
    s_waitcnt lgkmcnt(6)
    v_mfma_f32_16x16x32_bf16 v[88:91], v[44:47], v[140:143], v[88:91]
    s_waitcnt lgkmcnt(5)
    v_mfma_f32_16x16x32_bf16 v[88:91], v[48:51], v[144:147], v[88:91]
    s_waitcnt lgkmcnt(4)
    v_mfma_f32_16x16x32_bf16 v[88:91], v[52:55], v[148:151], v[88:91]
    v_add_u32 v1, s46, v1
    v_add_u32 v2, s46, v2
    v_add_u32 v3, s46, v3
    v_add_u32 v4, s46, v4
    v_add_u32 v7, s46, v7
    s_nop 2
    v_and_b32 v104, v23, v88
    v_and_b32 v105, v23, v89
    v_and_b32 v106, v23, v90
    v_and_b32 v107, v23, v91
    v_sub_f32 v104, v88, v104
    v_sub_f32 v105, v89, v105
    v_sub_f32 v106, v90, v106
    v_sub_f32 v107, v91, v107
    v_perm_b32 v168, v105, v104, s43
    v_perm_b32 v169, v107, v106, s43
    s_nop 1
    v_mfma_f32_16x16x16_bf16 v[152:155], v[32:33], v[168:169], v[152:155]
    v_mfma_f32_16x16x16_bf16 v[156:159], v[34:35], v[168:169], v[156:159]
    v_mfma_f32_16x16x16_bf16 v[160:163], v[36:37], v[168:169], v[160:163]
    v_mfma_f32_16x16x16_bf16 v[164:167], v[38:39], v[168:169], v[164:167]
    s_waitcnt lgkmcnt(0)
    s_barrier
    ds_read_b128 v[40:43], v1
    ds_read_b128 v[44:47], v2
    ds_read_b128 v[48:51], v3
    ds_read_b128 v[52:55], v4
    ds_read_b64 v[32:33], v7 offset:0
    ds_read_b64 v[34:35], v7 offset:2048
    ds_read_b64 v[36:37], v7 offset:4096
    ds_read_b64 v[38:39], v7 offset:6144
    s_waitcnt lgkmcnt(7)
    v_mfma_f32_16x16x32_bf16 v[88:91], v[40:43], v[136:139], 0
    s_waitcnt lgkmcnt(6)
    v_mfma_f32_16x16x32_bf16 v[88:91], v[44:47], v[140:143], v[88:91]
    s_waitcnt lgkmcnt(5)
    v_mfma_f32_16x16x32_bf16 v[88:91], v[48:51], v[144:147], v[88:91]
    s_waitcnt lgkmcnt(4)
    v_mfma_f32_16x16x32_bf16 v[88:91], v[52:55], v[148:151], v[88:91]
    v_add_u32 v1, s46, v1
    v_add_u32 v2, s46, v2
    v_add_u32 v3, s46, v3
    v_add_u32 v4, s46, v4
    v_add_u32 v7, s46, v7
    s_nop 2
    v_and_b32 v104, v23, v88
    v_and_b32 v105, v23, v89
    v_and_b32 v106, v23, v90
    v_and_b32 v107, v23, v91
    v_sub_f32 v104, v88, v104
    v_sub_f32 v105, v89, v105
    v_sub_f32 v106, v90, v106
    v_sub_f32 v107, v91, v107
    v_perm_b32 v168, v105, v104, s43
    v_perm_b32 v169, v107, v106, s43
    s_nop 1
    v_mfma_f32_16x16x16_bf16 v[152:155], v[24:25], v[168:169], v[152:155]
    v_mfma_f32_16x16x16_bf16 v[156:159], v[26:27], v[168:169], v[156:159]
    v_mfma_f32_16x16x16_bf16 v[160:163], v[28:29], v[168:169], v[160:163]
    v_mfma_f32_16x16x16_bf16 v[164:167], v[30:31], v[168:169], v[164:167]
    s_waitcnt lgkmcnt(0)
    s_barrier
    ds_read_b128 v[40:43], v1
    ds_read_b128 v[44:47], v2
    ds_read_b128 v[48:51], v3
    ds_read_b128 v[52:55], v4
    ds_read_b64 v[24:25], v7 offset:0
    ds_read_b64 v[26:27], v7 offset:2048
    ds_read_b64 v[28:29], v7 offset:4096
    ds_read_b64 v[30:31], v7 offset:6144
    s_waitcnt lgkmcnt(7)
    v_mfma_f32_16x16x32_bf16 v[88:91], v[40:43], v[136:139], 0
    s_waitcnt lgkmcnt(6)
    v_mfma_f32_16x16x32_bf16 v[88:91], v[44:47], v[140:143], v[88:91]
    s_waitcnt lgkmcnt(5)
    v_mfma_f32_16x16x32_bf16 v[88:91], v[48:51], v[144:147], v[88:91]
    s_waitcnt lgkmcnt(4)
    v_mfma_f32_16x16x32_bf16 v[88:91], v[52:55], v[148:151], v[88:91]
    v_add_u32 v1, s46, v1
    v_add_u32 v2, s46, v2
    v_add_u32 v3, s46, v3
    v_add_u32 v4, s46, v4
    v_add_u32 v7, s46, v7
    s_nop 2
    v_and_b32 v104, v23, v88
    v_and_b32 v105, v23, v89
    v_and_b32 v106, v23, v90
    v_and_b32 v107, v23, v91
    v_sub_f32 v104, v88, v104
    v_sub_f32 v105, v89, v105
    v_sub_f32 v106, v90, v106
    v_sub_f32 v107, v91, v107
    v_perm_b32 v168, v105, v104, s43
    v_perm_b32 v169, v107, v106, s43
    s_nop 1
    v_mfma_f32_16x16x16_bf16 v[152:155], v[32:33], v[168:169], v[152:155]
    v_mfma_f32_16x16x16_bf16 v[156:159], v[34:35], v[168:169], v[156:159]
    v_mfma_f32_16x16x16_bf16 v[160:163], v[36:37], v[168:169], v[160:163]
    v_mfma_f32_16x16x16_bf16 v[164:167], v[38:39], v[168:169], v[164:167]
    s_waitcnt lgkmcnt(0)
    s_barrier
    ds_read_b128 v[40:43], v1
    ds_read_b128 v[44:47], v2
    ds_read_b128 v[48:51], v3
    ds_read_b128 v[52:55], v4
    ds_read_b64 v[32:33], v7 offset:0
    ds_read_b64 v[34:35], v7 offset:2048
    ds_read_b64 v[36:37], v7 offset:4096
    ds_read_b64 v[38:39], v7 offset:6144
    s_waitcnt lgkmcnt(7)
    v_mfma_f32_16x16x32_bf16 v[88:91], v[40:43], v[136:139], 0
    s_waitcnt lgkmcnt(6)
    v_mfma_f32_16x16x32_bf16 v[88:91], v[44:47], v[140:143], v[88:91]
    s_waitcnt lgkmcnt(5)
    v_mfma_f32_16x16x32_bf16 v[88:91], v[48:51], v[144:147], v[88:91]
    s_waitcnt lgkmcnt(4)
    v_mfma_f32_16x16x32_bf16 v[88:91], v[52:55], v[148:151], v[88:91]
    v_add_u32 v1, s46, v1
    v_add_u32 v2, s46, v2
    v_add_u32 v3, s46, v3
    v_add_u32 v4, s46, v4
    v_add_u32 v7, s46, v7
    s_nop 2
    v_and_b32 v104, v23, v88
    v_and_b32 v105, v23, v89
    v_and_b32 v106, v23, v90
    v_and_b32 v107, v23, v91
    v_sub_f32 v104, v88, v104
    v_sub_f32 v105, v89, v105
    v_sub_f32 v106, v90, v106
    v_sub_f32 v107, v91, v107
    v_perm_b32 v168, v105, v104, s43
    v_perm_b32 v169, v107, v106, s43
    s_nop 1
    v_mfma_f32_16x16x16_bf16 v[152:155], v[24:25], v[168:169], v[152:155]
    v_mfma_f32_16x16x16_bf16 v[156:159], v[26:27], v[168:169], v[156:159]
    v_mfma_f32_16x16x16_bf16 v[160:163], v[28:29], v[168:169], v[160:163]
    v_mfma_f32_16x16x16_bf16 v[164:167], v[30:31], v[168:169], v[164:167]
    s_waitcnt lgkmcnt(0)
    s_barrier
    ds_read_b128 v[40:43], v1
    ds_read_b128 v[44:47], v2
    ds_read_b128 v[48:51], v3
    ds_read_b128 v[52:55], v4
    ds_read_b64 v[24:25], v7 offset:0
    ds_read_b64 v[26:27], v7 offset:2048
    ds_read_b64 v[28:29], v7 offset:4096
    ds_read_b64 v[30:31], v7 offset:6144
    s_waitcnt lgkmcnt(7)
    v_mfma_f32_16x16x32_bf16 v[88:91], v[40:43], v[136:139], 0
    s_waitcnt lgkmcnt(6)
    v_mfma_f32_16x16x32_bf16 v[88:91], v[44:47], v[140:143], v[88:91]
    s_waitcnt lgkmcnt(5)
    v_mfma_f32_16x16x32_bf16 v[88:91], v[48:51], v[144:147], v[88:91]
    s_waitcnt lgkmcnt(4)
    v_mfma_f32_16x16x32_bf16 v[88:91], v[52:55], v[148:151], v[88:91]
    v_add_u32 v1, s47, v1
    v_add_u32 v2, s47, v2
    v_add_u32 v3, s47, v3
    v_add_u32 v4, s47, v4
    v_add_u32 v7, s47, v7
    s_nop 2
    v_and_b32 v104, v23, v88
    v_and_b32 v105, v23, v89
    v_and_b32 v106, v23, v90
    v_and_b32 v107, v23, v91
    v_sub_f32 v104, v88, v104
    v_sub_f32 v105, v89, v105
    v_sub_f32 v106, v90, v106
    v_sub_f32 v107, v91, v107
    v_perm_b32 v168, v105, v104, s43
    v_perm_b32 v169, v107, v106, s43
    s_nop 1
    v_mfma_f32_16x16x16_bf16 v[152:155], v[32:33], v[168:169], v[152:155]
    v_mfma_f32_16x16x16_bf16 v[156:159], v[34:35], v[168:169], v[156:159]
    v_mfma_f32_16x16x16_bf16 v[160:163], v[36:37], v[168:169], v[160:163]
    v_mfma_f32_16x16x16_bf16 v[164:167], v[38:39], v[168:169], v[164:167]
    s_waitcnt lgkmcnt(0)
    s_barrier
    ds_read_b128 v[40:43], v1
    ds_read_b128 v[44:47], v2
    ds_read_b128 v[48:51], v3
    ds_read_b128 v[52:55], v4
    ds_read_b64 v[32:33], v7 offset:0
    ds_read_b64 v[34:35], v7 offset:2048
    ds_read_b64 v[36:37], v7 offset:4096
    ds_read_b64 v[38:39], v7 offset:6144
    s_waitcnt lgkmcnt(7)
    v_mfma_f32_16x16x32_bf16 v[88:91], v[40:43], v[136:139], 0
    s_waitcnt lgkmcnt(6)
    v_mfma_f32_16x16x32_bf16 v[88:91], v[44:47], v[140:143], v[88:91]
    s_waitcnt lgkmcnt(5)
    v_mfma_f32_16x16x32_bf16 v[88:91], v[48:51], v[144:147], v[88:91]
    s_waitcnt lgkmcnt(4)
    v_mfma_f32_16x16x32_bf16 v[88:91], v[52:55], v[148:151], v[88:91]
    v_add_u32 v1, s46, v1
    v_add_u32 v2, s46, v2
    v_add_u32 v3, s46, v3
    v_add_u32 v4, s46, v4
    v_add_u32 v7, s46, v7
    s_nop 2
    v_and_b32 v104, v23, v88
    v_and_b32 v105, v23, v89
    v_and_b32 v106, v23, v90
    v_and_b32 v107, v23, v91
    v_sub_f32 v104, v88, v104
    v_sub_f32 v105, v89, v105
    v_sub_f32 v106, v90, v106
    v_sub_f32 v107, v91, v107
    v_perm_b32 v168, v105, v104, s43
    v_perm_b32 v169, v107, v106, s43
    s_nop 1
    v_mfma_f32_16x16x16_bf16 v[152:155], v[24:25], v[168:169], v[152:155]
    v_mfma_f32_16x16x16_bf16 v[156:159], v[26:27], v[168:169], v[156:159]
    v_mfma_f32_16x16x16_bf16 v[160:163], v[28:29], v[168:169], v[160:163]
    v_mfma_f32_16x16x16_bf16 v[164:167], v[30:31], v[168:169], v[164:167]
    s_waitcnt lgkmcnt(0)
    s_barrier
    ds_read_b128 v[40:43], v1
    ds_read_b128 v[44:47], v2
    ds_read_b128 v[48:51], v3
    ds_read_b128 v[52:55], v4
    ds_read_b64 v[24:25], v7 offset:0
    ds_read_b64 v[26:27], v7 offset:2048
    ds_read_b64 v[28:29], v7 offset:4096
    ds_read_b64 v[30:31], v7 offset:6144
    s_waitcnt lgkmcnt(7)
    v_mfma_f32_16x16x32_bf16 v[88:91], v[40:43], v[136:139], 0
    s_waitcnt lgkmcnt(6)
    v_mfma_f32_16x16x32_bf16 v[88:91], v[44:47], v[140:143], v[88:91]
    s_waitcnt lgkmcnt(5)
    v_mfma_f32_16x16x32_bf16 v[88:91], v[48:51], v[144:147], v[88:91]
    s_waitcnt lgkmcnt(4)
    v_mfma_f32_16x16x32_bf16 v[88:91], v[52:55], v[148:151], v[88:91]
    v_add_u32 v1, s46, v1
    v_add_u32 v2, s46, v2
    v_add_u32 v3, s46, v3
    v_add_u32 v4, s46, v4
    v_add_u32 v7, s46, v7
    s_nop 2
    v_and_b32 v104, v23, v88
    v_and_b32 v105, v23, v89
    v_and_b32 v106, v23, v90
    v_and_b32 v107, v23, v91
    v_sub_f32 v104, v88, v104
    v_sub_f32 v105, v89, v105
    v_sub_f32 v106, v90, v106
    v_sub_f32 v107, v91, v107
    v_perm_b32 v168, v105, v104, s43
    v_perm_b32 v169, v107, v106, s43
    s_nop 1
    v_mfma_f32_16x16x16_bf16 v[152:155], v[32:33], v[168:169], v[152:155]
    v_mfma_f32_16x16x16_bf16 v[156:159], v[34:35], v[168:169], v[156:159]
    v_mfma_f32_16x16x16_bf16 v[160:163], v[36:37], v[168:169], v[160:163]
    v_mfma_f32_16x16x16_bf16 v[164:167], v[38:39], v[168:169], v[164:167]
    s_waitcnt lgkmcnt(0)
    s_barrier
    ds_read_b128 v[40:43], v1
    ds_read_b128 v[44:47], v2
    ds_read_b128 v[48:51], v3
    ds_read_b128 v[52:55], v4
    ds_read_b64 v[32:33], v7 offset:0
    ds_read_b64 v[34:35], v7 offset:2048
    ds_read_b64 v[36:37], v7 offset:4096
    ds_read_b64 v[38:39], v7 offset:6144
    s_waitcnt lgkmcnt(7)
    v_mfma_f32_16x16x32_bf16 v[88:91], v[40:43], v[136:139], 0
    s_waitcnt lgkmcnt(6)
    v_mfma_f32_16x16x32_bf16 v[88:91], v[44:47], v[140:143], v[88:91]
    s_waitcnt lgkmcnt(5)
    v_mfma_f32_16x16x32_bf16 v[88:91], v[48:51], v[144:147], v[88:91]
    s_waitcnt lgkmcnt(4)
    v_mfma_f32_16x16x32_bf16 v[88:91], v[52:55], v[148:151], v[88:91]
    v_add_u32 v1, s46, v1
    v_add_u32 v2, s46, v2
    v_add_u32 v3, s46, v3
    v_add_u32 v4, s46, v4
    v_add_u32 v7, s46, v7
    s_nop 2
    v_and_b32 v104, v23, v88
    v_and_b32 v105, v23, v89
    v_and_b32 v106, v23, v90
    v_and_b32 v107, v23, v91
    v_sub_f32 v104, v88, v104
    v_sub_f32 v105, v89, v105
    v_sub_f32 v106, v90, v106
    v_sub_f32 v107, v91, v107
    v_perm_b32 v168, v105, v104, s43
    v_perm_b32 v169, v107, v106, s43
    s_nop 1
    v_mfma_f32_16x16x16_bf16 v[152:155], v[24:25], v[168:169], v[152:155]
    v_mfma_f32_16x16x16_bf16 v[156:159], v[26:27], v[168:169], v[156:159]
    v_mfma_f32_16x16x16_bf16 v[160:163], v[28:29], v[168:169], v[160:163]
    v_mfma_f32_16x16x16_bf16 v[164:167], v[30:31], v[168:169], v[164:167]
    s_waitcnt lgkmcnt(0)
    s_barrier
    ds_read_b128 v[40:43], v1
    ds_read_b128 v[44:47], v2
    ds_read_b128 v[48:51], v3
    ds_read_b128 v[52:55], v4
    ds_read_b64 v[24:25], v7 offset:0
    ds_read_b64 v[26:27], v7 offset:2048
    ds_read_b64 v[28:29], v7 offset:4096
    ds_read_b64 v[30:31], v7 offset:6144
    s_waitcnt lgkmcnt(7)
    v_mfma_f32_16x16x32_bf16 v[88:91], v[40:43], v[136:139], 0
    s_waitcnt lgkmcnt(6)
    v_mfma_f32_16x16x32_bf16 v[88:91], v[44:47], v[140:143], v[88:91]
    s_waitcnt lgkmcnt(5)
    v_mfma_f32_16x16x32_bf16 v[88:91], v[48:51], v[144:147], v[88:91]
    s_waitcnt lgkmcnt(4)
    v_mfma_f32_16x16x32_bf16 v[88:91], v[52:55], v[148:151], v[88:91]
    v_add_u32 v1, s46, v1
    v_add_u32 v2, s46, v2
    v_add_u32 v3, s46, v3
    v_add_u32 v4, s46, v4
    v_add_u32 v7, s46, v7
    s_nop 2
    v_and_b32 v104, v23, v88
    v_and_b32 v105, v23, v89
    v_and_b32 v106, v23, v90
    v_and_b32 v107, v23, v91
    v_sub_f32 v104, v88, v104
    v_sub_f32 v105, v89, v105
    v_sub_f32 v106, v90, v106
    v_sub_f32 v107, v91, v107
    v_perm_b32 v168, v105, v104, s43
    v_perm_b32 v169, v107, v106, s43
    s_nop 1
    v_mfma_f32_16x16x16_bf16 v[152:155], v[32:33], v[168:169], v[152:155]
    v_mfma_f32_16x16x16_bf16 v[156:159], v[34:35], v[168:169], v[156:159]
    v_mfma_f32_16x16x16_bf16 v[160:163], v[36:37], v[168:169], v[160:163]
    v_mfma_f32_16x16x16_bf16 v[164:167], v[38:39], v[168:169], v[164:167]
    s_waitcnt lgkmcnt(0)
    s_barrier
    ds_read_b128 v[40:43], v1
    ds_read_b128 v[44:47], v2
    ds_read_b128 v[48:51], v3
    ds_read_b128 v[52:55], v4
    ds_read_b64 v[32:33], v7 offset:0
    ds_read_b64 v[34:35], v7 offset:2048
    ds_read_b64 v[36:37], v7 offset:4096
    ds_read_b64 v[38:39], v7 offset:6144
    s_waitcnt lgkmcnt(7)
    v_mfma_f32_16x16x32_bf16 v[88:91], v[40:43], v[136:139], 0
    s_waitcnt lgkmcnt(6)
    v_mfma_f32_16x16x32_bf16 v[88:91], v[44:47], v[140:143], v[88:91]
    s_waitcnt lgkmcnt(5)
    v_mfma_f32_16x16x32_bf16 v[88:91], v[48:51], v[144:147], v[88:91]
    s_waitcnt lgkmcnt(4)
    v_mfma_f32_16x16x32_bf16 v[88:91], v[52:55], v[148:151], v[88:91]
    v_add_u32 v1, s46, v1
    v_add_u32 v2, s46, v2
    v_add_u32 v3, s46, v3
    v_add_u32 v4, s46, v4
    v_add_u32 v7, s46, v7
    s_nop 2
    v_and_b32 v104, v23, v88
    v_and_b32 v105, v23, v89
    v_and_b32 v106, v23, v90
    v_and_b32 v107, v23, v91
    v_sub_f32 v104, v88, v104
    v_sub_f32 v105, v89, v105
    v_sub_f32 v106, v90, v106
    v_sub_f32 v107, v91, v107
    v_perm_b32 v168, v105, v104, s43
    v_perm_b32 v169, v107, v106, s43
    s_nop 1
    v_mfma_f32_16x16x16_bf16 v[152:155], v[24:25], v[168:169], v[152:155]
    v_mfma_f32_16x16x16_bf16 v[156:159], v[26:27], v[168:169], v[156:159]
    v_mfma_f32_16x16x16_bf16 v[160:163], v[28:29], v[168:169], v[160:163]
    v_mfma_f32_16x16x16_bf16 v[164:167], v[30:31], v[168:169], v[164:167]
    s_waitcnt lgkmcnt(0)
    s_barrier
    ds_read_b128 v[40:43], v1
    ds_read_b128 v[44:47], v2
    ds_read_b128 v[48:51], v3
    ds_read_b128 v[52:55], v4
    ds_read_b64 v[24:25], v7 offset:0
    ds_read_b64 v[26:27], v7 offset:2048
    ds_read_b64 v[28:29], v7 offset:4096
    ds_read_b64 v[30:31], v7 offset:6144
    s_waitcnt lgkmcnt(7)
    v_mfma_f32_16x16x32_bf16 v[88:91], v[40:43], v[136:139], 0
    s_waitcnt lgkmcnt(6)
    v_mfma_f32_16x16x32_bf16 v[88:91], v[44:47], v[140:143], v[88:91]
    s_waitcnt lgkmcnt(5)
    v_mfma_f32_16x16x32_bf16 v[88:91], v[48:51], v[144:147], v[88:91]
    s_waitcnt lgkmcnt(4)
    v_mfma_f32_16x16x32_bf16 v[88:91], v[52:55], v[148:151], v[88:91]
    v_add_u32 v1, s47, v1
    v_add_u32 v2, s47, v2
    v_add_u32 v3, s47, v3
    v_add_u32 v4, s47, v4
    v_add_u32 v7, s47, v7
    s_nop 2
    v_and_b32 v104, v23, v88
    v_and_b32 v105, v23, v89
    v_and_b32 v106, v23, v90
    v_and_b32 v107, v23, v91
    v_sub_f32 v104, v88, v104
    v_sub_f32 v105, v89, v105
    v_sub_f32 v106, v90, v106
    v_sub_f32 v107, v91, v107
    v_perm_b32 v168, v105, v104, s43
    v_perm_b32 v169, v107, v106, s43
    s_nop 1
    v_mfma_f32_16x16x16_bf16 v[152:155], v[32:33], v[168:169], v[152:155]
    v_mfma_f32_16x16x16_bf16 v[156:159], v[34:35], v[168:169], v[156:159]
    v_mfma_f32_16x16x16_bf16 v[160:163], v[36:37], v[168:169], v[160:163]
    v_mfma_f32_16x16x16_bf16 v[164:167], v[38:39], v[168:169], v[164:167]
    s_waitcnt lgkmcnt(0)
    s_barrier
    ds_read_b128 v[40:43], v1
    ds_read_b128 v[44:47], v2
    ds_read_b128 v[48:51], v3
    ds_read_b128 v[52:55], v4
    ds_read_b64 v[32:33], v7 offset:0
    ds_read_b64 v[34:35], v7 offset:2048
    ds_read_b64 v[36:37], v7 offset:4096
    ds_read_b64 v[38:39], v7 offset:6144
    s_waitcnt lgkmcnt(7)
    v_mfma_f32_16x16x32_bf16 v[88:91], v[40:43], v[136:139], 0
    s_waitcnt lgkmcnt(6)
    v_mfma_f32_16x16x32_bf16 v[88:91], v[44:47], v[140:143], v[88:91]
    s_waitcnt lgkmcnt(5)
    v_mfma_f32_16x16x32_bf16 v[88:91], v[48:51], v[144:147], v[88:91]
    s_waitcnt lgkmcnt(4)
    v_mfma_f32_16x16x32_bf16 v[88:91], v[52:55], v[148:151], v[88:91]
    v_add_u32 v1, s46, v1
    v_add_u32 v2, s46, v2
    v_add_u32 v3, s46, v3
    v_add_u32 v4, s46, v4
    v_add_u32 v7, s46, v7
    s_nop 2
    v_and_b32 v104, v23, v88
    v_and_b32 v105, v23, v89
    v_and_b32 v106, v23, v90
    v_and_b32 v107, v23, v91
    v_sub_f32 v104, v88, v104
    v_sub_f32 v105, v89, v105
    v_sub_f32 v106, v90, v106
    v_sub_f32 v107, v91, v107
    v_perm_b32 v168, v105, v104, s43
    v_perm_b32 v169, v107, v106, s43
    s_nop 1
    v_mfma_f32_16x16x16_bf16 v[152:155], v[24:25], v[168:169], v[152:155]
    v_mfma_f32_16x16x16_bf16 v[156:159], v[26:27], v[168:169], v[156:159]
    v_mfma_f32_16x16x16_bf16 v[160:163], v[28:29], v[168:169], v[160:163]
    v_mfma_f32_16x16x16_bf16 v[164:167], v[30:31], v[168:169], v[164:167]
    s_waitcnt lgkmcnt(0)
    s_barrier
    ds_read_b128 v[40:43], v1
    ds_read_b128 v[44:47], v2
    ds_read_b128 v[48:51], v3
    ds_read_b128 v[52:55], v4
    ds_read_b64 v[24:25], v7 offset:0
    ds_read_b64 v[26:27], v7 offset:2048
    ds_read_b64 v[28:29], v7 offset:4096
    ds_read_b64 v[30:31], v7 offset:6144
    s_waitcnt lgkmcnt(7)
    v_mfma_f32_16x16x32_bf16 v[88:91], v[40:43], v[136:139], 0
    s_waitcnt lgkmcnt(6)
    v_mfma_f32_16x16x32_bf16 v[88:91], v[44:47], v[140:143], v[88:91]
    s_waitcnt lgkmcnt(5)
    v_mfma_f32_16x16x32_bf16 v[88:91], v[48:51], v[144:147], v[88:91]
    s_waitcnt lgkmcnt(4)
    v_mfma_f32_16x16x32_bf16 v[88:91], v[52:55], v[148:151], v[88:91]
    v_add_u32 v1, s46, v1
    v_add_u32 v2, s46, v2
    v_add_u32 v3, s46, v3
    v_add_u32 v4, s46, v4
    v_add_u32 v7, s46, v7
    s_nop 2
    v_and_b32 v104, v23, v88
    v_and_b32 v105, v23, v89
    v_and_b32 v106, v23, v90
    v_and_b32 v107, v23, v91
    v_sub_f32 v104, v88, v104
    v_sub_f32 v105, v89, v105
    v_sub_f32 v106, v90, v106
    v_sub_f32 v107, v91, v107
    v_perm_b32 v168, v105, v104, s43
    v_perm_b32 v169, v107, v106, s43
    s_nop 1
    v_mfma_f32_16x16x16_bf16 v[152:155], v[32:33], v[168:169], v[152:155]
    v_mfma_f32_16x16x16_bf16 v[156:159], v[34:35], v[168:169], v[156:159]
    v_mfma_f32_16x16x16_bf16 v[160:163], v[36:37], v[168:169], v[160:163]
    v_mfma_f32_16x16x16_bf16 v[164:167], v[38:39], v[168:169], v[164:167]
    s_waitcnt lgkmcnt(0)
    s_barrier
    ds_read_b128 v[40:43], v1
    ds_read_b128 v[44:47], v2
    ds_read_b128 v[48:51], v3
    ds_read_b128 v[52:55], v4
    ds_read_b64 v[32:33], v7 offset:0
    ds_read_b64 v[34:35], v7 offset:2048
    ds_read_b64 v[36:37], v7 offset:4096
    ds_read_b64 v[38:39], v7 offset:6144
    s_waitcnt lgkmcnt(7)
    v_mfma_f32_16x16x32_bf16 v[88:91], v[40:43], v[136:139], 0
    s_waitcnt lgkmcnt(6)
    v_mfma_f32_16x16x32_bf16 v[88:91], v[44:47], v[140:143], v[88:91]
    s_waitcnt lgkmcnt(5)
    v_mfma_f32_16x16x32_bf16 v[88:91], v[48:51], v[144:147], v[88:91]
    s_waitcnt lgkmcnt(4)
    v_mfma_f32_16x16x32_bf16 v[88:91], v[52:55], v[148:151], v[88:91]
    v_add_u32 v1, s46, v1
    v_add_u32 v2, s46, v2
    v_add_u32 v3, s46, v3
    v_add_u32 v4, s46, v4
    v_add_u32 v7, s46, v7
    s_nop 2
    v_and_b32 v104, v23, v88
    v_and_b32 v105, v23, v89
    v_and_b32 v106, v23, v90
    v_and_b32 v107, v23, v91
    v_sub_f32 v104, v88, v104
    v_sub_f32 v105, v89, v105
    v_sub_f32 v106, v90, v106
    v_sub_f32 v107, v91, v107
    v_perm_b32 v168, v105, v104, s43
    v_perm_b32 v169, v107, v106, s43
    s_nop 1
    v_mfma_f32_16x16x16_bf16 v[152:155], v[24:25], v[168:169], v[152:155]
    v_mfma_f32_16x16x16_bf16 v[156:159], v[26:27], v[168:169], v[156:159]
    v_mfma_f32_16x16x16_bf16 v[160:163], v[28:29], v[168:169], v[160:163]
    v_mfma_f32_16x16x16_bf16 v[164:167], v[30:31], v[168:169], v[164:167]
    s_waitcnt lgkmcnt(0)
    s_barrier
    ds_read_b128 v[40:43], v1
    ds_read_b128 v[44:47], v2
    ds_read_b128 v[48:51], v3
    ds_read_b128 v[52:55], v4
    ds_read_b64 v[24:25], v7 offset:0
    ds_read_b64 v[26:27], v7 offset:2048
    ds_read_b64 v[28:29], v7 offset:4096
    ds_read_b64 v[30:31], v7 offset:6144
    s_waitcnt lgkmcnt(7)
    v_mfma_f32_16x16x32_bf16 v[88:91], v[40:43], v[136:139], 0
    s_waitcnt lgkmcnt(6)
    v_mfma_f32_16x16x32_bf16 v[88:91], v[44:47], v[140:143], v[88:91]
    s_waitcnt lgkmcnt(5)
    v_mfma_f32_16x16x32_bf16 v[88:91], v[48:51], v[144:147], v[88:91]
    s_waitcnt lgkmcnt(4)
    v_mfma_f32_16x16x32_bf16 v[88:91], v[52:55], v[148:151], v[88:91]
    v_add_u32 v1, s46, v1
    v_add_u32 v2, s46, v2
    v_add_u32 v3, s46, v3
    v_add_u32 v4, s46, v4
    v_add_u32 v7, s46, v7
    s_nop 2
    v_and_b32 v104, v23, v88
    v_and_b32 v105, v23, v89
    v_and_b32 v106, v23, v90
    v_and_b32 v107, v23, v91
    v_sub_f32 v104, v88, v104
    v_sub_f32 v105, v89, v105
    v_sub_f32 v106, v90, v106
    v_sub_f32 v107, v91, v107
    v_perm_b32 v168, v105, v104, s43
    v_perm_b32 v169, v107, v106, s43
    s_nop 1
    v_mfma_f32_16x16x16_bf16 v[152:155], v[32:33], v[168:169], v[152:155]
    v_mfma_f32_16x16x16_bf16 v[156:159], v[34:35], v[168:169], v[156:159]
    v_mfma_f32_16x16x16_bf16 v[160:163], v[36:37], v[168:169], v[160:163]
    v_mfma_f32_16x16x16_bf16 v[164:167], v[38:39], v[168:169], v[164:167]
    s_waitcnt lgkmcnt(0)
    s_barrier
    ds_read_b128 v[40:43], v1
    ds_read_b128 v[44:47], v2
    ds_read_b128 v[48:51], v3
    ds_read_b128 v[52:55], v4
    ds_read_b64 v[32:33], v7 offset:0
    ds_read_b64 v[34:35], v7 offset:2048
    ds_read_b64 v[36:37], v7 offset:4096
    ds_read_b64 v[38:39], v7 offset:6144
    s_waitcnt lgkmcnt(7)
    v_mfma_f32_16x16x32_bf16 v[88:91], v[40:43], v[136:139], 0
    s_waitcnt lgkmcnt(6)
    v_mfma_f32_16x16x32_bf16 v[88:91], v[44:47], v[140:143], v[88:91]
    s_waitcnt lgkmcnt(5)
    v_mfma_f32_16x16x32_bf16 v[88:91], v[48:51], v[144:147], v[88:91]
    s_waitcnt lgkmcnt(4)
    v_mfma_f32_16x16x32_bf16 v[88:91], v[52:55], v[148:151], v[88:91]
    v_add_u32 v1, s46, v1
    v_add_u32 v2, s46, v2
    v_add_u32 v3, s46, v3
    v_add_u32 v4, s46, v4
    v_add_u32 v7, s46, v7
    s_nop 2
    v_and_b32 v104, v23, v88
    v_and_b32 v105, v23, v89
    v_and_b32 v106, v23, v90
    v_and_b32 v107, v23, v91
    v_sub_f32 v104, v88, v104
    v_sub_f32 v105, v89, v105
    v_sub_f32 v106, v90, v106
    v_sub_f32 v107, v91, v107
    v_perm_b32 v168, v105, v104, s43
    v_perm_b32 v169, v107, v106, s43
    s_nop 1
    v_mfma_f32_16x16x16_bf16 v[152:155], v[24:25], v[168:169], v[152:155]
    v_mfma_f32_16x16x16_bf16 v[156:159], v[26:27], v[168:169], v[156:159]
    v_mfma_f32_16x16x16_bf16 v[160:163], v[28:29], v[168:169], v[160:163]
    v_mfma_f32_16x16x16_bf16 v[164:167], v[30:31], v[168:169], v[164:167]
    s_waitcnt lgkmcnt(0)
    s_barrier
    ds_read_b128 v[40:43], v1
    ds_read_b128 v[44:47], v2
    ds_read_b128 v[48:51], v3
    ds_read_b128 v[52:55], v4
    ds_read_b64 v[24:25], v7 offset:0
    ds_read_b64 v[26:27], v7 offset:2048
    ds_read_b64 v[28:29], v7 offset:4096
    ds_read_b64 v[30:31], v7 offset:6144
    s_waitcnt lgkmcnt(7)
    v_mfma_f32_16x16x32_bf16 v[88:91], v[40:43], v[136:139], 0
    s_waitcnt lgkmcnt(6)
    v_mfma_f32_16x16x32_bf16 v[88:91], v[44:47], v[140:143], v[88:91]
    s_waitcnt lgkmcnt(5)
    v_mfma_f32_16x16x32_bf16 v[88:91], v[48:51], v[144:147], v[88:91]
    s_waitcnt lgkmcnt(4)
    v_mfma_f32_16x16x32_bf16 v[88:91], v[52:55], v[148:151], v[88:91]
    v_add_u32 v1, s47, v1
    v_add_u32 v2, s47, v2
    v_add_u32 v3, s47, v3
    v_add_u32 v4, s47, v4
    v_add_u32 v7, s47, v7
    s_nop 2
    v_and_b32 v104, v23, v88
    v_and_b32 v105, v23, v89
    v_and_b32 v106, v23, v90
    v_and_b32 v107, v23, v91
    v_sub_f32 v104, v88, v104
    v_sub_f32 v105, v89, v105
    v_sub_f32 v106, v90, v106
    v_sub_f32 v107, v91, v107
    v_perm_b32 v168, v105, v104, s43
    v_perm_b32 v169, v107, v106, s43
    s_nop 1
    v_mfma_f32_16x16x16_bf16 v[152:155], v[32:33], v[168:169], v[152:155]
    v_mfma_f32_16x16x16_bf16 v[156:159], v[34:35], v[168:169], v[156:159]
    v_mfma_f32_16x16x16_bf16 v[160:163], v[36:37], v[168:169], v[160:163]
    v_mfma_f32_16x16x16_bf16 v[164:167], v[38:39], v[168:169], v[164:167]
    s_waitcnt lgkmcnt(0)
    s_barrier
    ds_read_b128 v[40:43], v1
    ds_read_b128 v[44:47], v2
    ds_read_b128 v[48:51], v3
    ds_read_b128 v[52:55], v4
    ds_read_b64 v[32:33], v7 offset:0
    ds_read_b64 v[34:35], v7 offset:2048
    ds_read_b64 v[36:37], v7 offset:4096
    ds_read_b64 v[38:39], v7 offset:6144
    s_waitcnt lgkmcnt(7)
    v_mfma_f32_16x16x32_bf16 v[88:91], v[40:43], v[136:139], 0
    s_waitcnt lgkmcnt(6)
    v_mfma_f32_16x16x32_bf16 v[88:91], v[44:47], v[140:143], v[88:91]
    s_waitcnt lgkmcnt(5)
    v_mfma_f32_16x16x32_bf16 v[88:91], v[48:51], v[144:147], v[88:91]
    s_waitcnt lgkmcnt(4)
    v_mfma_f32_16x16x32_bf16 v[88:91], v[52:55], v[148:151], v[88:91]
    v_add_u32 v1, s46, v1
    v_add_u32 v2, s46, v2
    v_add_u32 v3, s46, v3
    v_add_u32 v4, s46, v4
    v_add_u32 v7, s46, v7
    s_nop 2
    v_and_b32 v104, v23, v88
    v_and_b32 v105, v23, v89
    v_and_b32 v106, v23, v90
    v_and_b32 v107, v23, v91
    v_sub_f32 v104, v88, v104
    v_sub_f32 v105, v89, v105
    v_sub_f32 v106, v90, v106
    v_sub_f32 v107, v91, v107
    v_perm_b32 v168, v105, v104, s43
    v_perm_b32 v169, v107, v106, s43
    s_nop 1
    v_mfma_f32_16x16x16_bf16 v[152:155], v[24:25], v[168:169], v[152:155]
    v_mfma_f32_16x16x16_bf16 v[156:159], v[26:27], v[168:169], v[156:159]
    v_mfma_f32_16x16x16_bf16 v[160:163], v[28:29], v[168:169], v[160:163]
    v_mfma_f32_16x16x16_bf16 v[164:167], v[30:31], v[168:169], v[164:167]
    s_waitcnt lgkmcnt(0)
    s_barrier
    ds_read_b128 v[40:43], v1
    ds_read_b128 v[44:47], v2
    ds_read_b128 v[48:51], v3
    ds_read_b128 v[52:55], v4
    ds_read_b64 v[24:25], v7 offset:0
    ds_read_b64 v[26:27], v7 offset:2048
    ds_read_b64 v[28:29], v7 offset:4096
    ds_read_b64 v[30:31], v7 offset:6144
    s_waitcnt lgkmcnt(7)
    v_mfma_f32_16x16x32_bf16 v[88:91], v[40:43], v[136:139], 0
    s_waitcnt lgkmcnt(6)
    v_mfma_f32_16x16x32_bf16 v[88:91], v[44:47], v[140:143], v[88:91]
    s_waitcnt lgkmcnt(5)
    v_mfma_f32_16x16x32_bf16 v[88:91], v[48:51], v[144:147], v[88:91]
    s_waitcnt lgkmcnt(4)
    v_mfma_f32_16x16x32_bf16 v[88:91], v[52:55], v[148:151], v[88:91]
    v_add_u32 v1, s46, v1
    v_add_u32 v2, s46, v2
    v_add_u32 v3, s46, v3
    v_add_u32 v4, s46, v4
    v_add_u32 v7, s46, v7
    s_nop 2
    v_and_b32 v104, v23, v88
    v_and_b32 v105, v23, v89
    v_and_b32 v106, v23, v90
    v_and_b32 v107, v23, v91
    v_sub_f32 v104, v88, v104
    v_sub_f32 v105, v89, v105
    v_sub_f32 v106, v90, v106
    v_sub_f32 v107, v91, v107
    v_perm_b32 v168, v105, v104, s43
    v_perm_b32 v169, v107, v106, s43
    s_nop 1
    v_mfma_f32_16x16x16_bf16 v[152:155], v[32:33], v[168:169], v[152:155]
    v_mfma_f32_16x16x16_bf16 v[156:159], v[34:35], v[168:169], v[156:159]
    v_mfma_f32_16x16x16_bf16 v[160:163], v[36:37], v[168:169], v[160:163]
    v_mfma_f32_16x16x16_bf16 v[164:167], v[38:39], v[168:169], v[164:167]
    s_waitcnt lgkmcnt(0)
    s_barrier
    ds_read_b128 v[40:43], v1
    ds_read_b128 v[44:47], v2
    ds_read_b128 v[48:51], v3
    ds_read_b128 v[52:55], v4
    ds_read_b64 v[32:33], v7 offset:0
    ds_read_b64 v[34:35], v7 offset:2048
    ds_read_b64 v[36:37], v7 offset:4096
    ds_read_b64 v[38:39], v7 offset:6144
    s_waitcnt lgkmcnt(7)
    v_mfma_f32_16x16x32_bf16 v[88:91], v[40:43], v[136:139], 0
    s_waitcnt lgkmcnt(6)
    v_mfma_f32_16x16x32_bf16 v[88:91], v[44:47], v[140:143], v[88:91]
    s_waitcnt lgkmcnt(5)
    v_mfma_f32_16x16x32_bf16 v[88:91], v[48:51], v[144:147], v[88:91]
    s_waitcnt lgkmcnt(4)
    v_mfma_f32_16x16x32_bf16 v[88:91], v[52:55], v[148:151], v[88:91]
    v_add_u32 v1, s46, v1
    v_add_u32 v2, s46, v2
    v_add_u32 v3, s46, v3
    v_add_u32 v4, s46, v4
    v_add_u32 v7, s46, v7
    s_nop 2
    v_and_b32 v104, v23, v88
    v_and_b32 v105, v23, v89
    v_and_b32 v106, v23, v90
    v_and_b32 v107, v23, v91
    v_sub_f32 v104, v88, v104
    v_sub_f32 v105, v89, v105
    v_sub_f32 v106, v90, v106
    v_sub_f32 v107, v91, v107
    v_perm_b32 v168, v105, v104, s43
    v_perm_b32 v169, v107, v106, s43
    s_nop 1
    v_mfma_f32_16x16x16_bf16 v[152:155], v[24:25], v[168:169], v[152:155]
    v_mfma_f32_16x16x16_bf16 v[156:159], v[26:27], v[168:169], v[156:159]
    v_mfma_f32_16x16x16_bf16 v[160:163], v[28:29], v[168:169], v[160:163]
    v_mfma_f32_16x16x16_bf16 v[164:167], v[30:31], v[168:169], v[164:167]
    s_waitcnt lgkmcnt(0)
    s_barrier
    ds_read_b128 v[40:43], v1
    ds_read_b128 v[44:47], v2
    ds_read_b128 v[48:51], v3
    ds_read_b128 v[52:55], v4
    ds_read_b64 v[24:25], v7 offset:0
    ds_read_b64 v[26:27], v7 offset:2048
    ds_read_b64 v[28:29], v7 offset:4096
    ds_read_b64 v[30:31], v7 offset:6144
    s_waitcnt lgkmcnt(7)
    v_mfma_f32_16x16x32_bf16 v[88:91], v[40:43], v[136:139], 0
    s_waitcnt lgkmcnt(6)
    v_mfma_f32_16x16x32_bf16 v[88:91], v[44:47], v[140:143], v[88:91]
    s_waitcnt lgkmcnt(5)
    v_mfma_f32_16x16x32_bf16 v[88:91], v[48:51], v[144:147], v[88:91]
    s_waitcnt lgkmcnt(4)
    v_mfma_f32_16x16x32_bf16 v[88:91], v[52:55], v[148:151], v[88:91]
    v_add_u32 v1, s46, v1
    v_add_u32 v2, s46, v2
    v_add_u32 v3, s46, v3
    v_add_u32 v4, s46, v4
    v_add_u32 v7, s46, v7
    s_nop 2
    v_and_b32 v104, v23, v88
    v_and_b32 v105, v23, v89
    v_and_b32 v106, v23, v90
    v_and_b32 v107, v23, v91
    v_sub_f32 v104, v88, v104
    v_sub_f32 v105, v89, v105
    v_sub_f32 v106, v90, v106
    v_sub_f32 v107, v91, v107
    v_perm_b32 v168, v105, v104, s43
    v_perm_b32 v169, v107, v106, s43
    s_nop 1
    v_mfma_f32_16x16x16_bf16 v[152:155], v[32:33], v[168:169], v[152:155]
    v_mfma_f32_16x16x16_bf16 v[156:159], v[34:35], v[168:169], v[156:159]
    v_mfma_f32_16x16x16_bf16 v[160:163], v[36:37], v[168:169], v[160:163]
    v_mfma_f32_16x16x16_bf16 v[164:167], v[38:39], v[168:169], v[164:167]
    s_waitcnt lgkmcnt(0)
    s_barrier
    ds_read_b128 v[40:43], v1
    ds_read_b128 v[44:47], v2
    ds_read_b128 v[48:51], v3
    ds_read_b128 v[52:55], v4
    ds_read_b64 v[32:33], v7 offset:0
    ds_read_b64 v[34:35], v7 offset:2048
    ds_read_b64 v[36:37], v7 offset:4096
    ds_read_b64 v[38:39], v7 offset:6144
    s_waitcnt lgkmcnt(7)
    v_mfma_f32_16x16x32_bf16 v[88:91], v[40:43], v[136:139], 0
    s_waitcnt lgkmcnt(6)
    v_mfma_f32_16x16x32_bf16 v[88:91], v[44:47], v[140:143], v[88:91]
    s_waitcnt lgkmcnt(5)
    v_mfma_f32_16x16x32_bf16 v[88:91], v[48:51], v[144:147], v[88:91]
    s_waitcnt lgkmcnt(4)
    v_mfma_f32_16x16x32_bf16 v[88:91], v[52:55], v[148:151], v[88:91]
    v_add_u32 v1, s46, v1
    v_add_u32 v2, s46, v2
    v_add_u32 v3, s46, v3
    v_add_u32 v4, s46, v4
    v_add_u32 v7, s46, v7
    s_nop 2
    v_and_b32 v104, v23, v88
    v_and_b32 v105, v23, v89
    v_and_b32 v106, v23, v90
    v_and_b32 v107, v23, v91
    v_sub_f32 v104, v88, v104
    v_sub_f32 v105, v89, v105
    v_sub_f32 v106, v90, v106
    v_sub_f32 v107, v91, v107
    v_perm_b32 v168, v105, v104, s43
    v_perm_b32 v169, v107, v106, s43
    s_nop 1
    v_mfma_f32_16x16x16_bf16 v[152:155], v[24:25], v[168:169], v[152:155]
    v_mfma_f32_16x16x16_bf16 v[156:159], v[26:27], v[168:169], v[156:159]
    v_mfma_f32_16x16x16_bf16 v[160:163], v[28:29], v[168:169], v[160:163]
    v_mfma_f32_16x16x16_bf16 v[164:167], v[30:31], v[168:169], v[164:167]
    s_waitcnt lgkmcnt(0)
    s_barrier
    ds_read_b128 v[40:43], v1
    ds_read_b128 v[44:47], v2
    ds_read_b128 v[48:51], v3
    ds_read_b128 v[52:55], v4
    ds_read_b64 v[24:25], v7 offset:0
    ds_read_b64 v[26:27], v7 offset:2048
    ds_read_b64 v[28:29], v7 offset:4096
    ds_read_b64 v[30:31], v7 offset:6144
    s_waitcnt lgkmcnt(7)
    v_mfma_f32_16x16x32_bf16 v[88:91], v[40:43], v[136:139], 0
    s_waitcnt lgkmcnt(6)
    v_mfma_f32_16x16x32_bf16 v[88:91], v[44:47], v[140:143], v[88:91]
    s_waitcnt lgkmcnt(5)
    v_mfma_f32_16x16x32_bf16 v[88:91], v[48:51], v[144:147], v[88:91]
    s_waitcnt lgkmcnt(4)
    v_mfma_f32_16x16x32_bf16 v[88:91], v[52:55], v[148:151], v[88:91]
    v_add_u32 v1, s47, v1
    v_add_u32 v2, s47, v2
    v_add_u32 v3, s47, v3
    v_add_u32 v4, s47, v4
    v_add_u32 v7, s47, v7
    s_nop 2
    v_and_b32 v104, v23, v88
    v_and_b32 v105, v23, v89
    v_and_b32 v106, v23, v90
    v_and_b32 v107, v23, v91
    v_sub_f32 v104, v88, v104
    v_sub_f32 v105, v89, v105
    v_sub_f32 v106, v90, v106
    v_sub_f32 v107, v91, v107
    v_perm_b32 v168, v105, v104, s43
    v_perm_b32 v169, v107, v106, s43
    s_nop 1
    v_mfma_f32_16x16x16_bf16 v[152:155], v[32:33], v[168:169], v[152:155]
    v_mfma_f32_16x16x16_bf16 v[156:159], v[34:35], v[168:169], v[156:159]
    v_mfma_f32_16x16x16_bf16 v[160:163], v[36:37], v[168:169], v[160:163]
    v_mfma_f32_16x16x16_bf16 v[164:167], v[38:39], v[168:169], v[164:167]
    s_waitcnt lgkmcnt(0)
    s_barrier
    ds_read_b128 v[40:43], v1
    ds_read_b128 v[44:47], v2
    ds_read_b128 v[48:51], v3
    ds_read_b128 v[52:55], v4
    ds_read_b64 v[32:33], v7 offset:0
    ds_read_b64 v[34:35], v7 offset:2048
    ds_read_b64 v[36:37], v7 offset:4096
    ds_read_b64 v[38:39], v7 offset:6144
    s_waitcnt lgkmcnt(7)
    v_mfma_f32_16x16x32_bf16 v[88:91], v[40:43], v[136:139], 0
    s_waitcnt lgkmcnt(6)
    v_mfma_f32_16x16x32_bf16 v[88:91], v[44:47], v[140:143], v[88:91]
    s_waitcnt lgkmcnt(5)
    v_mfma_f32_16x16x32_bf16 v[88:91], v[48:51], v[144:147], v[88:91]
    s_waitcnt lgkmcnt(4)
    v_mfma_f32_16x16x32_bf16 v[88:91], v[52:55], v[148:151], v[88:91]
    v_add_u32 v1, s46, v1
    v_add_u32 v2, s46, v2
    v_add_u32 v3, s46, v3
    v_add_u32 v4, s46, v4
    v_add_u32 v7, s46, v7
    s_nop 2
    v_and_b32 v104, v23, v88
    v_and_b32 v105, v23, v89
    v_and_b32 v106, v23, v90
    v_and_b32 v107, v23, v91
    v_sub_f32 v104, v88, v104
    v_sub_f32 v105, v89, v105
    v_sub_f32 v106, v90, v106
    v_sub_f32 v107, v91, v107
    v_perm_b32 v168, v105, v104, s43
    v_perm_b32 v169, v107, v106, s43
    s_nop 1
    v_mfma_f32_16x16x16_bf16 v[152:155], v[24:25], v[168:169], v[152:155]
    v_mfma_f32_16x16x16_bf16 v[156:159], v[26:27], v[168:169], v[156:159]
    v_mfma_f32_16x16x16_bf16 v[160:163], v[28:29], v[168:169], v[160:163]
    v_mfma_f32_16x16x16_bf16 v[164:167], v[30:31], v[168:169], v[164:167]
    s_waitcnt lgkmcnt(0)
    s_barrier
    ds_read_b128 v[40:43], v1
    ds_read_b128 v[44:47], v2
    ds_read_b128 v[48:51], v3
    ds_read_b128 v[52:55], v4
    ds_read_b64 v[24:25], v7 offset:0
    ds_read_b64 v[26:27], v7 offset:2048
    ds_read_b64 v[28:29], v7 offset:4096
    ds_read_b64 v[30:31], v7 offset:6144
    s_waitcnt lgkmcnt(7)
    v_mfma_f32_16x16x32_bf16 v[88:91], v[40:43], v[136:139], 0
    s_waitcnt lgkmcnt(6)
    v_mfma_f32_16x16x32_bf16 v[88:91], v[44:47], v[140:143], v[88:91]
    s_waitcnt lgkmcnt(5)
    v_mfma_f32_16x16x32_bf16 v[88:91], v[48:51], v[144:147], v[88:91]
    s_waitcnt lgkmcnt(4)
    v_mfma_f32_16x16x32_bf16 v[88:91], v[52:55], v[148:151], v[88:91]
    v_add_u32 v1, s46, v1
    v_add_u32 v2, s46, v2
    v_add_u32 v3, s46, v3
    v_add_u32 v4, s46, v4
    v_add_u32 v7, s46, v7
    s_nop 2
    v_and_b32 v104, v23, v88
    v_and_b32 v105, v23, v89
    v_and_b32 v106, v23, v90
    v_and_b32 v107, v23, v91
    v_sub_f32 v104, v88, v104
    v_sub_f32 v105, v89, v105
    v_sub_f32 v106, v90, v106
    v_sub_f32 v107, v91, v107
    v_perm_b32 v168, v105, v104, s43
    v_perm_b32 v169, v107, v106, s43
    s_nop 1
    v_mfma_f32_16x16x16_bf16 v[152:155], v[32:33], v[168:169], v[152:155]
    v_mfma_f32_16x16x16_bf16 v[156:159], v[34:35], v[168:169], v[156:159]
    v_mfma_f32_16x16x16_bf16 v[160:163], v[36:37], v[168:169], v[160:163]
    v_mfma_f32_16x16x16_bf16 v[164:167], v[38:39], v[168:169], v[164:167]
    s_waitcnt lgkmcnt(0)
    s_barrier
    ds_read_b128 v[40:43], v1
    ds_read_b128 v[44:47], v2
    ds_read_b128 v[48:51], v3
    ds_read_b128 v[52:55], v4
    ds_read_b64 v[32:33], v7 offset:0
    ds_read_b64 v[34:35], v7 offset:2048
    ds_read_b64 v[36:37], v7 offset:4096
    ds_read_b64 v[38:39], v7 offset:6144
    s_waitcnt lgkmcnt(7)
    v_mfma_f32_16x16x32_bf16 v[88:91], v[40:43], v[136:139], 0
    s_waitcnt lgkmcnt(6)
    v_mfma_f32_16x16x32_bf16 v[88:91], v[44:47], v[140:143], v[88:91]
    s_waitcnt lgkmcnt(5)
    v_mfma_f32_16x16x32_bf16 v[88:91], v[48:51], v[144:147], v[88:91]
    s_waitcnt lgkmcnt(4)
    v_mfma_f32_16x16x32_bf16 v[88:91], v[52:55], v[148:151], v[88:91]
    v_add_u32 v1, s46, v1
    v_add_u32 v2, s46, v2
    v_add_u32 v3, s46, v3
    v_add_u32 v4, s46, v4
    v_add_u32 v7, s46, v7
    s_nop 2
    v_and_b32 v104, v23, v88
    v_and_b32 v105, v23, v89
    v_and_b32 v106, v23, v90
    v_and_b32 v107, v23, v91
    v_sub_f32 v104, v88, v104
    v_sub_f32 v105, v89, v105
    v_sub_f32 v106, v90, v106
    v_sub_f32 v107, v91, v107
    v_perm_b32 v168, v105, v104, s43
    v_perm_b32 v169, v107, v106, s43
    s_nop 1
    v_mfma_f32_16x16x16_bf16 v[152:155], v[24:25], v[168:169], v[152:155]
    v_mfma_f32_16x16x16_bf16 v[156:159], v[26:27], v[168:169], v[156:159]
    v_mfma_f32_16x16x16_bf16 v[160:163], v[28:29], v[168:169], v[160:163]
    v_mfma_f32_16x16x16_bf16 v[164:167], v[30:31], v[168:169], v[164:167]
    s_waitcnt lgkmcnt(0)
    s_barrier
    ds_read_b128 v[40:43], v1
    ds_read_b128 v[44:47], v2
    ds_read_b128 v[48:51], v3
    ds_read_b128 v[52:55], v4
    ds_read_b64 v[24:25], v7 offset:0
    ds_read_b64 v[26:27], v7 offset:2048
    ds_read_b64 v[28:29], v7 offset:4096
    ds_read_b64 v[30:31], v7 offset:6144
    s_waitcnt lgkmcnt(7)
    v_mfma_f32_16x16x32_bf16 v[88:91], v[40:43], v[136:139], 0
    s_waitcnt lgkmcnt(6)
    v_mfma_f32_16x16x32_bf16 v[88:91], v[44:47], v[140:143], v[88:91]
    s_waitcnt lgkmcnt(5)
    v_mfma_f32_16x16x32_bf16 v[88:91], v[48:51], v[144:147], v[88:91]
    s_waitcnt lgkmcnt(4)
    v_mfma_f32_16x16x32_bf16 v[88:91], v[52:55], v[148:151], v[88:91]
    v_add_u32 v1, s46, v1
    v_add_u32 v2, s46, v2
    v_add_u32 v3, s46, v3
    v_add_u32 v4, s46, v4
    v_add_u32 v7, s46, v7
    s_nop 2
    v_and_b32 v104, v23, v88
    v_and_b32 v105, v23, v89
    v_and_b32 v106, v23, v90
    v_and_b32 v107, v23, v91
    v_sub_f32 v104, v88, v104
    v_sub_f32 v105, v89, v105
    v_sub_f32 v106, v90, v106
    v_sub_f32 v107, v91, v107
    v_perm_b32 v168, v105, v104, s43
    v_perm_b32 v169, v107, v106, s43
    s_nop 1
    v_mfma_f32_16x16x16_bf16 v[152:155], v[32:33], v[168:169], v[152:155]
    v_mfma_f32_16x16x16_bf16 v[156:159], v[34:35], v[168:169], v[156:159]
    v_mfma_f32_16x16x16_bf16 v[160:163], v[36:37], v[168:169], v[160:163]
    v_mfma_f32_16x16x16_bf16 v[164:167], v[38:39], v[168:169], v[164:167]
    s_waitcnt lgkmcnt(0)
    s_barrier
    ds_read_b128 v[40:43], v1
    ds_read_b128 v[44:47], v2
    ds_read_b128 v[48:51], v3
    ds_read_b128 v[52:55], v4
    ds_read_b64 v[32:33], v7 offset:0
    ds_read_b64 v[34:35], v7 offset:2048
    ds_read_b64 v[36:37], v7 offset:4096
    ds_read_b64 v[38:39], v7 offset:6144
    s_waitcnt lgkmcnt(7)
    v_mfma_f32_16x16x32_bf16 v[88:91], v[40:43], v[136:139], 0
    s_waitcnt lgkmcnt(6)
    v_mfma_f32_16x16x32_bf16 v[88:91], v[44:47], v[140:143], v[88:91]
    s_waitcnt lgkmcnt(5)
    v_mfma_f32_16x16x32_bf16 v[88:91], v[48:51], v[144:147], v[88:91]
    s_waitcnt lgkmcnt(4)
    v_mfma_f32_16x16x32_bf16 v[88:91], v[52:55], v[148:151], v[88:91]
    v_add_u32 v1, s46, v1
    v_add_u32 v2, s46, v2
    v_add_u32 v3, s46, v3
    v_add_u32 v4, s46, v4
    v_add_u32 v7, s46, v7
    s_nop 2
    v_and_b32 v104, v23, v88
    v_and_b32 v105, v23, v89
    v_and_b32 v106, v23, v90
    v_and_b32 v107, v23, v91
    v_sub_f32 v104, v88, v104
    v_sub_f32 v105, v89, v105
    v_sub_f32 v106, v90, v106
    v_sub_f32 v107, v91, v107
    v_perm_b32 v168, v105, v104, s43
    v_perm_b32 v169, v107, v106, s43
    s_nop 1
    v_mfma_f32_16x16x16_bf16 v[152:155], v[24:25], v[168:169], v[152:155]
    v_mfma_f32_16x16x16_bf16 v[156:159], v[26:27], v[168:169], v[156:159]
    v_mfma_f32_16x16x16_bf16 v[160:163], v[28:29], v[168:169], v[160:163]
    v_mfma_f32_16x16x16_bf16 v[164:167], v[30:31], v[168:169], v[164:167]
    s_waitcnt lgkmcnt(0)
    s_barrier
    ds_read_b128 v[40:43], v1
    ds_read_b128 v[44:47], v2
    ds_read_b128 v[48:51], v3
    ds_read_b128 v[52:55], v4
    ds_read_b64 v[24:25], v7 offset:0
    ds_read_b64 v[26:27], v7 offset:2048
    ds_read_b64 v[28:29], v7 offset:4096
    ds_read_b64 v[30:31], v7 offset:6144
    s_waitcnt lgkmcnt(7)
    v_mfma_f32_16x16x32_bf16 v[88:91], v[40:43], v[136:139], 0
    s_waitcnt lgkmcnt(6)
    v_mfma_f32_16x16x32_bf16 v[88:91], v[44:47], v[140:143], v[88:91]
    s_waitcnt lgkmcnt(5)
    v_mfma_f32_16x16x32_bf16 v[88:91], v[48:51], v[144:147], v[88:91]
    s_waitcnt lgkmcnt(4)
    v_mfma_f32_16x16x32_bf16 v[88:91], v[52:55], v[148:151], v[88:91]
    v_add_u32 v1, s47, v1
    v_add_u32 v2, s47, v2
    v_add_u32 v3, s47, v3
    v_add_u32 v4, s47, v4
    v_add_u32 v7, s47, v7
    s_nop 2
    v_and_b32 v104, v23, v88
    v_and_b32 v105, v23, v89
    v_and_b32 v106, v23, v90
    v_and_b32 v107, v23, v91
    v_sub_f32 v104, v88, v104
    v_sub_f32 v105, v89, v105
    v_sub_f32 v106, v90, v106
    v_sub_f32 v107, v91, v107
    v_perm_b32 v168, v105, v104, s43
    v_perm_b32 v169, v107, v106, s43
    s_nop 1
    v_mfma_f32_16x16x16_bf16 v[152:155], v[32:33], v[168:169], v[152:155]
    v_mfma_f32_16x16x16_bf16 v[156:159], v[34:35], v[168:169], v[156:159]
    v_mfma_f32_16x16x16_bf16 v[160:163], v[36:37], v[168:169], v[160:163]
    v_mfma_f32_16x16x16_bf16 v[164:167], v[38:39], v[168:169], v[164:167]
    s_waitcnt lgkmcnt(0)
    s_barrier
    ds_read_b128 v[40:43], v1
    ds_read_b128 v[44:47], v2
    ds_read_b128 v[48:51], v3
    ds_read_b128 v[52:55], v4
    ds_read_b64 v[32:33], v7 offset:0
    ds_read_b64 v[34:35], v7 offset:2048
    ds_read_b64 v[36:37], v7 offset:4096
    ds_read_b64 v[38:39], v7 offset:6144
    s_waitcnt lgkmcnt(7)
    v_mfma_f32_16x16x32_bf16 v[88:91], v[40:43], v[136:139], 0
    s_waitcnt lgkmcnt(6)
    v_mfma_f32_16x16x32_bf16 v[88:91], v[44:47], v[140:143], v[88:91]
    s_waitcnt lgkmcnt(5)
    v_mfma_f32_16x16x32_bf16 v[88:91], v[48:51], v[144:147], v[88:91]
    s_waitcnt lgkmcnt(4)
    v_mfma_f32_16x16x32_bf16 v[88:91], v[52:55], v[148:151], v[88:91]
    v_add_u32 v1, s46, v1
    v_add_u32 v2, s46, v2
    v_add_u32 v3, s46, v3
    v_add_u32 v4, s46, v4
    v_add_u32 v7, s46, v7
    s_nop 2
    v_and_b32 v104, v23, v88
    v_and_b32 v105, v23, v89
    v_and_b32 v106, v23, v90
    v_and_b32 v107, v23, v91
    v_sub_f32 v104, v88, v104
    v_sub_f32 v105, v89, v105
    v_sub_f32 v106, v90, v106
    v_sub_f32 v107, v91, v107
    v_perm_b32 v168, v105, v104, s43
    v_perm_b32 v169, v107, v106, s43
    s_nop 1
    v_mfma_f32_16x16x16_bf16 v[152:155], v[24:25], v[168:169], v[152:155]
    v_mfma_f32_16x16x16_bf16 v[156:159], v[26:27], v[168:169], v[156:159]
    v_mfma_f32_16x16x16_bf16 v[160:163], v[28:29], v[168:169], v[160:163]
    v_mfma_f32_16x16x16_bf16 v[164:167], v[30:31], v[168:169], v[164:167]
    s_waitcnt lgkmcnt(0)
    s_barrier
    ds_read_b128 v[40:43], v1
    ds_read_b128 v[44:47], v2
    ds_read_b128 v[48:51], v3
    ds_read_b128 v[52:55], v4
    ds_read_b64_tr_b16 v[184:185], v8 offset:0
    ds_read_b64_tr_b16 v[186:187], v8 offset:2048
    ds_read_b64_tr_b16 v[188:189], v8 offset:4096
    ds_read_b64_tr_b16 v[190:191], v8 offset:6144
    ds_read_b64_tr_b16 v[192:193], v9 offset:0
    ds_read_b64_tr_b16 v[194:195], v9 offset:2048
    ds_read_b64_tr_b16 v[196:197], v9 offset:4096
    ds_read_b64_tr_b16 v[198:199], v9 offset:6144
    s_waitcnt lgkmcnt(11)
    v_mfma_f32_16x16x32_bf16 v[88:91], v[40:43], v[136:139], 0
    s_waitcnt lgkmcnt(10)
    v_mfma_f32_16x16x32_bf16 v[88:91], v[44:47], v[140:143], v[88:91]
    s_waitcnt lgkmcnt(9)
    v_mfma_f32_16x16x32_bf16 v[88:91], v[48:51], v[144:147], v[88:91]
    s_waitcnt lgkmcnt(8)
    v_mfma_f32_16x16x32_bf16 v[88:91], v[52:55], v[148:151], v[88:91]
    s_waitcnt lgkmcnt(0)
    ds_read_b64_tr_b16 v[200:201], v10 offset:0
    ds_read_b64_tr_b16 v[202:203], v10 offset:2048
    ds_read_b64_tr_b16 v[204:205], v10 offset:4096
    ds_read_b64_tr_b16 v[206:207], v10 offset:6144
    ds_read_b64_tr_b16 v[208:209], v11 offset:0
    ds_read_b64_tr_b16 v[210:211], v11 offset:2048
    ds_read_b64_tr_b16 v[212:213], v11 offset:4096
    ds_read_b64_tr_b16 v[214:215], v11 offset:6144
    v_add_u32 v8, s46, v8
    v_add_u32 v9, s46, v9
    v_add_u32 v10, s46, v10
    v_add_u32 v11, s46, v11
    v_and_b32 v104, v23, v88
    v_and_b32 v105, v23, v89
    v_and_b32 v106, v23, v90
    v_and_b32 v107, v23, v91
    v_sub_f32 v104, v88, v104
    v_sub_f32 v105, v89, v105
    v_sub_f32 v106, v90, v106
    v_sub_f32 v107, v91, v107
    v_perm_b32 v168, v105, v104, s43
    v_perm_b32 v169, v107, v106, s43
    s_nop 1
    v_mfma_f32_16x16x16_bf16 v[152:155], v[32:33], v[168:169], v[152:155]
    v_mfma_f32_16x16x16_bf16 v[156:159], v[34:35], v[168:169], v[156:159]
    v_mfma_f32_16x16x16_bf16 v[160:163], v[36:37], v[168:169], v[160:163]
    v_mfma_f32_16x16x16_bf16 v[164:167], v[38:39], v[168:169], v[164:167]
    s_waitcnt lgkmcnt(0)
    s_nop 6
    v_add_f32_dpp v152, v152, v152 row_shl:4 row_mask:0xf bank_mask:0xf
    v_add_f32_dpp v153, v153, v153 row_shl:4 row_mask:0xf bank_mask:0xf
    v_add_f32_dpp v154, v154, v154 row_shl:4 row_mask:0xf bank_mask:0xf
    v_add_f32_dpp v155, v155, v155 row_shl:4 row_mask:0xf bank_mask:0xf
    v_add_f32_dpp v156, v156, v156 row_shl:4 row_mask:0xf bank_mask:0xf
    v_add_f32_dpp v157, v157, v157 row_shl:4 row_mask:0xf bank_mask:0xf
    v_add_f32_dpp v158, v158, v158 row_shl:4 row_mask:0xf bank_mask:0xf
    v_add_f32_dpp v159, v159, v159 row_shl:4 row_mask:0xf bank_mask:0xf
    v_add_f32_dpp v160, v160, v160 row_shl:4 row_mask:0xf bank_mask:0xf
    v_add_f32_dpp v161, v161, v161 row_shl:4 row_mask:0xf bank_mask:0xf
    v_add_f32_dpp v162, v162, v162 row_shl:4 row_mask:0xf bank_mask:0xf
    v_add_f32_dpp v163, v163, v163 row_shl:4 row_mask:0xf bank_mask:0xf
    v_add_f32_dpp v164, v164, v164 row_shl:4 row_mask:0xf bank_mask:0xf
    v_add_f32_dpp v165, v165, v165 row_shl:4 row_mask:0xf bank_mask:0xf
    v_add_f32_dpp v166, v166, v166 row_shl:4 row_mask:0xf bank_mask:0xf
    v_add_f32_dpp v167, v167, v167 row_shl:4 row_mask:0xf bank_mask:0xf
    s_mov_b32 s52, 0x000f000f
    s_mov_b32 s53, 0x000f000f
    s_mov_b64 exec, s[52:53]
    ds_write_b128 v15, v[152:155] offset:0
    ds_write_b128 v15, v[156:159] offset:256
    ds_write_b128 v15, v[160:163] offset:512
    ds_write_b128 v15, v[164:167] offset:768
    s_mov_b64 exec, -1
    s_waitcnt lgkmcnt(0)
    s_barrier
    ds_read_b128 v[24:27], v19 offset:0
    ds_read_b128 v[28:31], v19 offset:256
    ds_read_b128 v[32:35], v19 offset:512
    ds_read_b128 v[36:39], v19 offset:768
    ds_read_b128 v[40:43], v19 offset:1024
    ds_read_b128 v[44:47], v19 offset:1280
    ds_read_b128 v[48:51], v19 offset:1536
    ds_read_b128 v[52:55], v19 offset:1792
    ds_read_b128 v[56:59], v19 offset:2048
    ds_read_b128 v[60:63], v19 offset:2304
    ds_read_b128 v[64:67], v19 offset:2560
    ds_read_b128 v[68:71], v19 offset:2816
    ds_read_b128 v[72:75], v19 offset:3072
    ds_read_b128 v[76:79], v19 offset:3328
    ds_read_b128 v[80:83], v19 offset:3584
    ds_read_b128 v[84:87], v19 offset:3840
    s_mov_b32 s54, 0xffff0000
    s_mov_b32 s51, 0x3db504f3
    s_waitcnt lgkmcnt(8)
    v_pk_add_f32 v[24:25], v[24:25], v[40:41]
    v_pk_add_f32 v[26:27], v[26:27], v[42:43]
    v_pk_add_f32 v[28:29], v[28:29], v[44:45]
    v_pk_add_f32 v[30:31], v[30:31], v[46:47]
    v_pk_add_f32 v[32:33], v[32:33], v[48:49]
    v_pk_add_f32 v[34:35], v[34:35], v[50:51]
    v_pk_add_f32 v[36:37], v[36:37], v[52:53]
    v_pk_add_f32 v[38:39], v[38:39], v[54:55]
    s_waitcnt lgkmcnt(0)
    v_pk_add_f32 v[56:57], v[56:57], v[72:73]
    v_pk_add_f32 v[58:59], v[58:59], v[74:75]
    v_pk_add_f32 v[60:61], v[60:61], v[76:77]
    v_pk_add_f32 v[62:63], v[62:63], v[78:79]
    v_pk_add_f32 v[64:65], v[64:65], v[80:81]
    v_pk_add_f32 v[66:67], v[66:67], v[82:83]
    v_pk_add_f32 v[68:69], v[68:69], v[84:85]
    v_pk_add_f32 v[70:71], v[70:71], v[86:87]
    v_pk_add_f32 v[24:25], v[24:25], v[56:57]
    v_pk_add_f32 v[26:27], v[26:27], v[58:59]
    v_pk_add_f32 v[28:29], v[28:29], v[60:61]
    v_pk_add_f32 v[30:31], v[30:31], v[62:63]
    v_pk_add_f32 v[32:33], v[32:33], v[64:65]
    v_pk_add_f32 v[34:35], v[34:35], v[66:67]
    v_pk_add_f32 v[36:37], v[36:37], v[68:69]
    v_pk_add_f32 v[38:39], v[38:39], v[70:71]
    v_cvt_pk_bf16_f32 v40, v24, v25
    v_cvt_pk_bf16_f32 v41, v26, v27
    v_cvt_pk_bf16_f32 v42, v28, v29
    v_cvt_pk_bf16_f32 v43, v30, v31
    v_cvt_pk_bf16_f32 v44, v32, v33
    v_cvt_pk_bf16_f32 v45, v34, v35
    v_cvt_pk_bf16_f32 v46, v36, v37
    v_cvt_pk_bf16_f32 v47, v38, v39
    v_lshlrev_b32 v24, 16, v40
    v_and_b32 v25, s54, v40
    v_lshlrev_b32 v26, 16, v41
    v_and_b32 v27, s54, v41
    v_lshlrev_b32 v28, 16, v42
    v_and_b32 v29, s54, v42
    v_lshlrev_b32 v30, 16, v43
    v_and_b32 v31, s54, v43
    v_lshlrev_b32 v32, 16, v44
    v_and_b32 v33, s54, v44
    v_lshlrev_b32 v34, 16, v45
    v_and_b32 v35, s54, v45
    v_lshlrev_b32 v36, 16, v46
    v_and_b32 v37, s54, v46
    v_lshlrev_b32 v38, 16, v47
    v_and_b32 v39, s54, v47
    v_mul_f32 v24, s51, v24
    v_mul_f32 v25, s51, v25
    v_mul_f32 v26, s51, v26
    v_mul_f32 v27, s51, v27
    v_mul_f32 v28, s51, v28
    v_mul_f32 v29, s51, v29
    v_mul_f32 v30, s51, v30
    v_mul_f32 v31, s51, v31
    v_mul_f32 v32, s51, v32
    v_mul_f32 v33, s51, v33
    v_mul_f32 v34, s51, v34
    v_mul_f32 v35, s51, v35
    v_mul_f32 v36, s51, v36
    v_mul_f32 v37, s51, v37
    v_mul_f32 v38, s51, v38
    v_mul_f32 v39, s51, v39
    v_cvt_pk_bf16_f32 v40, v24, v25
    v_cvt_pk_bf16_f32 v41, v26, v27
    v_cvt_pk_bf16_f32 v42, v28, v29
    v_cvt_pk_bf16_f32 v43, v30, v31
    v_cvt_pk_bf16_f32 v44, v32, v33
    v_cvt_pk_bf16_f32 v45, v34, v35
    v_cvt_pk_bf16_f32 v46, v36, v37
    v_cvt_pk_bf16_f32 v47, v38, v39
    v_lshlrev_b32 v24, 16, v40
    v_and_b32 v25, s54, v40
    v_lshlrev_b32 v26, 16, v41
    v_and_b32 v27, s54, v41
    v_lshlrev_b32 v28, 16, v42
    v_and_b32 v29, s54, v42
    v_lshlrev_b32 v30, 16, v43
    v_and_b32 v31, s54, v43
    v_lshlrev_b32 v32, 16, v44
    v_and_b32 v33, s54, v44
    v_lshlrev_b32 v34, 16, v45
    v_and_b32 v35, s54, v45
    v_lshlrev_b32 v36, 16, v46
    v_and_b32 v37, s54, v46
    v_lshlrev_b32 v38, 16, v47
    v_and_b32 v39, s54, v47
    v_max3_f32 v56, v24, v25, v26
    v_max3_f32 v56, v56, v27, v28
    v_max3_f32 v56, v56, v29, v30
    v_max3_f32 v56, v56, v31, v32
    v_max3_f32 v56, v56, v33, v34
    v_max3_f32 v56, v56, v35, v36
    v_max3_f32 v56, v56, v37, v38
    v_max_f32 v56, v56, v39
    v_mov_b32 v57, v56
    s_nop 1
    v_permlane16_swap_b32 v56, v57
    s_nop 1
    v_max_f32 v56, v56, v57
    v_mov_b32 v57, v56
    s_nop 1
    v_permlane32_swap_b32 v56, v57
    s_nop 1
    v_max_f32 v56, v56, v57
    s_barrier
    s_mov_b32 s51, 0x3fb8aa3b
    v_sub_f32 v24, v24, v56
    v_sub_f32 v25, v25, v56
    v_sub_f32 v26, v26, v56
    v_sub_f32 v27, v27, v56
    v_sub_f32 v28, v28, v56
    v_sub_f32 v29, v29, v56
    v_sub_f32 v30, v30, v56
    v_sub_f32 v31, v31, v56
    v_sub_f32 v32, v32, v56
    v_sub_f32 v33, v33, v56
    v_sub_f32 v34, v34, v56
    v_sub_f32 v35, v35, v56
    v_sub_f32 v36, v36, v56
    v_sub_f32 v37, v37, v56
    v_sub_f32 v38, v38, v56
    v_sub_f32 v39, v39, v56
    v_mul_f32 v24, s51, v24
    v_mul_f32 v25, s51, v25
    v_mul_f32 v26, s51, v26
    v_mul_f32 v27, s51, v27
    v_mul_f32 v28, s51, v28
    v_mul_f32 v29, s51, v29
    v_mul_f32 v30, s51, v30
    v_mul_f32 v31, s51, v31
    v_mul_f32 v32, s51, v32
    v_mul_f32 v33, s51, v33
    v_mul_f32 v34, s51, v34
    v_mul_f32 v35, s51, v35
    v_mul_f32 v36, s51, v36
    v_mul_f32 v37, s51, v37
    v_mul_f32 v38, s51, v38
    v_mul_f32 v39, s51, v39
    v_exp_f32 v24, v24
    v_exp_f32 v25, v25
    v_exp_f32 v26, v26
    v_exp_f32 v27, v27
    v_exp_f32 v28, v28
    v_exp_f32 v29, v29
    v_exp_f32 v30, v30
    v_exp_f32 v31, v31
    v_exp_f32 v32, v32
    v_exp_f32 v33, v33
    v_exp_f32 v34, v34
    v_exp_f32 v35, v35
    v_exp_f32 v36, v36
    v_exp_f32 v37, v37
    v_exp_f32 v38, v38
    v_exp_f32 v39, v39
    s_nop 0
    v_add_f32 v56, v24, v25
    v_add_f32 v56, v56, v26
    v_add_f32 v56, v56, v27
    v_add_f32 v56, v56, v28
    v_add_f32 v56, v56, v29
    v_add_f32 v56, v56, v30
    v_add_f32 v56, v56, v31
    v_add_f32 v56, v56, v32
    v_add_f32 v56, v56, v33
    v_add_f32 v56, v56, v34
    v_add_f32 v56, v56, v35
    v_add_f32 v56, v56, v36
    v_add_f32 v56, v56, v37
    v_add_f32 v56, v56, v38
    v_add_f32 v56, v56, v39
    v_mov_b32 v57, v56
    s_nop 1
    v_permlane16_swap_b32 v56, v57
    s_nop 1
    v_add_f32 v56, v56, v57
    v_mov_b32 v57, v56
    s_nop 1
    v_permlane32_swap_b32 v56, v57
    s_nop 1
    v_add_f32 v56, v56, v57
    v_rcp_f32 v56, v56
    s_nop 0
    v_mul_f32 v24, v24, v56
    v_mul_f32 v25, v25, v56
    v_mul_f32 v26, v26, v56
    v_mul_f32 v27, v27, v56
    v_mul_f32 v28, v28, v56
    v_mul_f32 v29, v29, v56
    v_mul_f32 v30, v30, v56
    v_mul_f32 v31, v31, v56
    v_mul_f32 v32, v32, v56
    v_mul_f32 v33, v33, v56
    v_mul_f32 v34, v34, v56
    v_mul_f32 v35, v35, v56
    v_mul_f32 v36, v36, v56
    v_mul_f32 v37, v37, v56
    v_mul_f32 v38, v38, v56
    v_mul_f32 v39, v39, v56
    v_cvt_pk_bf16_f32 v120, v24, v25
    v_cvt_pk_bf16_f32 v121, v26, v27
    v_cvt_pk_bf16_f32 v122, v28, v29
    v_cvt_pk_bf16_f32 v123, v30, v31
    v_cvt_pk_bf16_f32 v124, v32, v33
    v_cvt_pk_bf16_f32 v125, v34, v35
    v_cvt_pk_bf16_f32 v126, v36, v37
    v_cvt_pk_bf16_f32 v127, v38, v39
    s_nop 1
    v_mfma_f32_16x16x32_bf16 v[88:91], v[184:187], v[120:123], 0
    v_mfma_f32_16x16x32_bf16 v[88:91], v[188:191], v[124:127], v[88:91]
    v_mfma_f32_16x16x32_bf16 v[92:95], v[192:195], v[120:123], 0
    v_mfma_f32_16x16x32_bf16 v[92:95], v[196:199], v[124:127], v[92:95]
    v_mfma_f32_16x16x32_bf16 v[96:99], v[200:203], v[120:123], 0
    v_mfma_f32_16x16x32_bf16 v[96:99], v[204:207], v[124:127], v[96:99]
    v_mfma_f32_16x16x32_bf16 v[100:103], v[208:211], v[120:123], 0
    v_mfma_f32_16x16x32_bf16 v[100:103], v[212:215], v[124:127], v[100:103]
    s_nop 7
    v_and_b32 v104, v23, v88
    v_and_b32 v105, v23, v89
    v_and_b32 v106, v23, v90
    v_and_b32 v107, v23, v91
    v_and_b32 v108, v23, v92
    v_and_b32 v109, v23, v93
    v_and_b32 v110, v23, v94
    v_and_b32 v111, v23, v95
    v_and_b32 v112, v23, v96
    v_and_b32 v113, v23, v97
    v_and_b32 v114, v23, v98
    v_and_b32 v115, v23, v99
    v_and_b32 v116, v23, v100
    v_and_b32 v117, v23, v101
    v_and_b32 v118, v23, v102
    v_and_b32 v119, v23, v103
    v_sub_f32 v104, v88, v104
    v_sub_f32 v105, v89, v105
    v_sub_f32 v106, v90, v106
    v_sub_f32 v107, v91, v107
    v_sub_f32 v108, v92, v108
    v_sub_f32 v109, v93, v109
    v_sub_f32 v110, v94, v110
    v_sub_f32 v111, v95, v111
    v_sub_f32 v112, v96, v112
    v_sub_f32 v113, v97, v113
    v_sub_f32 v114, v98, v114
    v_sub_f32 v115, v99, v115
    v_sub_f32 v116, v100, v116
    v_sub_f32 v117, v101, v117
    v_sub_f32 v118, v102, v118
    v_sub_f32 v119, v103, v119
    v_perm_b32 v168, v105, v104, s43
    v_perm_b32 v169, v107, v106, s43
    v_perm_b32 v170, v109, v108, s43
    v_perm_b32 v171, v111, v110, s43
    v_perm_b32 v172, v113, v112, s43
    v_perm_b32 v173, v115, v114, s43
    v_perm_b32 v174, v117, v116, s43
    v_perm_b32 v175, v119, v118, s43
    s_barrier
    ds_read_b64_tr_b16 v[40:41], v5 offset:0
    ds_read_b64_tr_b16 v[42:43], v5 offset:4096
    ds_read_b64_tr_b16 v[44:45], v6 offset:0
    ds_read_b64_tr_b16 v[46:47], v6 offset:4096
    ds_read_b64_tr_b16 v[48:49], v5 offset:8192
    ds_read_b64_tr_b16 v[50:51], v5 offset:12288
    ds_read_b64_tr_b16 v[52:53], v6 offset:8192
    ds_read_b64_tr_b16 v[54:55], v6 offset:12288
    ds_read_b64_tr_b16 v[184:185], v8 offset:0
    ds_read_b64_tr_b16 v[186:187], v8 offset:2048
    ds_read_b64_tr_b16 v[188:189], v8 offset:4096
    ds_read_b64_tr_b16 v[190:191], v8 offset:6144
    s_waitcnt lgkmcnt(10)
    v_mfma_f32_16x16x32_bf16 v[128:131], v[40:43], v[168:171], 0
    s_waitcnt lgkmcnt(8)
    v_mfma_f32_16x16x32_bf16 v[132:135], v[44:47], v[168:171], 0
    s_waitcnt lgkmcnt(6)
    v_mfma_f32_16x16x32_bf16 v[128:131], v[48:51], v[172:175], v[128:131]
    s_waitcnt lgkmcnt(4)
    v_mfma_f32_16x16x32_bf16 v[132:135], v[52:55], v[172:175], v[132:135]
    ds_read_b64_tr_b16 v[192:193], v9 offset:0
    ds_read_b64_tr_b16 v[194:195], v9 offset:2048
    ds_read_b64_tr_b16 v[196:197], v9 offset:4096
    ds_read_b64_tr_b16 v[198:199], v9 offset:6144
    ds_read_b64_tr_b16 v[200:201], v10 offset:0
    ds_read_b64_tr_b16 v[202:203], v10 offset:2048
    ds_read_b64_tr_b16 v[204:205], v10 offset:4096
    ds_read_b64_tr_b16 v[206:207], v10 offset:6144
    s_waitcnt lgkmcnt(8)
    v_mfma_f32_16x16x32_bf16 v[88:91], v[184:187], v[120:123], 0
    v_mfma_f32_16x16x32_bf16 v[88:91], v[188:191], v[124:127], v[88:91]
    ds_read_b64_tr_b16 v[208:209], v11 offset:0
    ds_read_b64_tr_b16 v[210:211], v11 offset:2048
    ds_read_b64_tr_b16 v[212:213], v11 offset:4096
    ds_read_b64_tr_b16 v[214:215], v11 offset:6144
    s_waitcnt lgkmcnt(8)
    v_mfma_f32_16x16x32_bf16 v[92:95], v[192:195], v[120:123], 0
    v_mfma_f32_16x16x32_bf16 v[92:95], v[196:199], v[124:127], v[92:95]
    s_waitcnt lgkmcnt(4)
    v_mfma_f32_16x16x32_bf16 v[96:99], v[200:203], v[120:123], 0
    v_mfma_f32_16x16x32_bf16 v[96:99], v[204:207], v[124:127], v[96:99]
    s_waitcnt lgkmcnt(0)
    v_mfma_f32_16x16x32_bf16 v[100:103], v[208:211], v[120:123], 0
    v_mfma_f32_16x16x32_bf16 v[100:103], v[212:215], v[124:127], v[100:103]
    v_add_u32 v5, s46, v5
    v_add_u32 v6, s46, v6
    v_add_u32 v8, s46, v8
    v_add_u32 v9, s46, v9
    v_add_u32 v10, s46, v10
    v_add_u32 v11, s46, v11
    s_nop 1
    v_and_b32 v104, v23, v88
    v_and_b32 v105, v23, v89
    v_and_b32 v106, v23, v90
    v_and_b32 v107, v23, v91
    v_and_b32 v108, v23, v92
    v_and_b32 v109, v23, v93
    v_and_b32 v110, v23, v94
    v_and_b32 v111, v23, v95
    v_and_b32 v112, v23, v96
    v_and_b32 v113, v23, v97
    v_and_b32 v114, v23, v98
    v_and_b32 v115, v23, v99
    v_and_b32 v116, v23, v100
    v_and_b32 v117, v23, v101
    v_and_b32 v118, v23, v102
    v_and_b32 v119, v23, v103
    v_sub_f32 v104, v88, v104
    v_sub_f32 v105, v89, v105
    v_sub_f32 v106, v90, v106
    v_sub_f32 v107, v91, v107
    v_sub_f32 v108, v92, v108
    v_sub_f32 v109, v93, v109
    v_sub_f32 v110, v94, v110
    v_sub_f32 v111, v95, v111
    v_sub_f32 v112, v96, v112
    v_sub_f32 v113, v97, v113
    v_sub_f32 v114, v98, v114
    v_sub_f32 v115, v99, v115
    v_sub_f32 v116, v100, v116
    v_sub_f32 v117, v101, v117
    v_sub_f32 v118, v102, v118
    v_sub_f32 v119, v103, v119
    v_perm_b32 v176, v105, v104, s43
    v_perm_b32 v177, v107, v106, s43
    v_perm_b32 v178, v109, v108, s43
    v_perm_b32 v179, v111, v110, s43
    v_perm_b32 v180, v113, v112, s43
    v_perm_b32 v181, v115, v114, s43
    v_perm_b32 v182, v117, v116, s43
    v_perm_b32 v183, v119, v118, s43
    ds_read_b64_tr_b16 v[40:41], v5 offset:0
    ds_read_b64_tr_b16 v[42:43], v5 offset:4096
    ds_read_b64_tr_b16 v[44:45], v6 offset:0
    ds_read_b64_tr_b16 v[46:47], v6 offset:4096
    ds_read_b64_tr_b16 v[48:49], v5 offset:8192
    ds_read_b64_tr_b16 v[50:51], v5 offset:12288
    ds_read_b64_tr_b16 v[52:53], v6 offset:8192
    ds_read_b64_tr_b16 v[54:55], v6 offset:12288
    ds_read_b64_tr_b16 v[184:185], v8 offset:0
    ds_read_b64_tr_b16 v[186:187], v8 offset:2048
    ds_read_b64_tr_b16 v[188:189], v8 offset:4096
    ds_read_b64_tr_b16 v[190:191], v8 offset:6144
    s_waitcnt lgkmcnt(10)
    v_mfma_f32_16x16x32_bf16 v[128:131], v[40:43], v[176:179], v[128:131]
    s_waitcnt lgkmcnt(8)
    v_mfma_f32_16x16x32_bf16 v[132:135], v[44:47], v[176:179], v[132:135]
    s_waitcnt lgkmcnt(6)
    v_mfma_f32_16x16x32_bf16 v[128:131], v[48:51], v[180:183], v[128:131]
    s_waitcnt lgkmcnt(4)
    v_mfma_f32_16x16x32_bf16 v[132:135], v[52:55], v[180:183], v[132:135]
    ds_read_b64_tr_b16 v[192:193], v9 offset:0
    ds_read_b64_tr_b16 v[194:195], v9 offset:2048
    ds_read_b64_tr_b16 v[196:197], v9 offset:4096
    ds_read_b64_tr_b16 v[198:199], v9 offset:6144
    ds_read_b64_tr_b16 v[200:201], v10 offset:0
    ds_read_b64_tr_b16 v[202:203], v10 offset:2048
    ds_read_b64_tr_b16 v[204:205], v10 offset:4096
    ds_read_b64_tr_b16 v[206:207], v10 offset:6144
    s_waitcnt lgkmcnt(8)
    v_mfma_f32_16x16x32_bf16 v[88:91], v[184:187], v[120:123], 0
    v_mfma_f32_16x16x32_bf16 v[88:91], v[188:191], v[124:127], v[88:91]
    ds_read_b64_tr_b16 v[208:209], v11 offset:0
    ds_read_b64_tr_b16 v[210:211], v11 offset:2048
    ds_read_b64_tr_b16 v[212:213], v11 offset:4096
    ds_read_b64_tr_b16 v[214:215], v11 offset:6144
    s_waitcnt lgkmcnt(8)
    v_mfma_f32_16x16x32_bf16 v[92:95], v[192:195], v[120:123], 0
    v_mfma_f32_16x16x32_bf16 v[92:95], v[196:199], v[124:127], v[92:95]
    s_waitcnt lgkmcnt(4)
    v_mfma_f32_16x16x32_bf16 v[96:99], v[200:203], v[120:123], 0
    v_mfma_f32_16x16x32_bf16 v[96:99], v[204:207], v[124:127], v[96:99]
    s_waitcnt lgkmcnt(0)
    v_mfma_f32_16x16x32_bf16 v[100:103], v[208:211], v[120:123], 0
    v_mfma_f32_16x16x32_bf16 v[100:103], v[212:215], v[124:127], v[100:103]
    v_add_u32 v5, s46, v5
    v_add_u32 v6, s46, v6
    v_add_u32 v8, s46, v8
    v_add_u32 v9, s46, v9
    v_add_u32 v10, s46, v10
    v_add_u32 v11, s46, v11
    s_nop 1
    v_and_b32 v104, v23, v88
    v_and_b32 v105, v23, v89
    v_and_b32 v106, v23, v90
    v_and_b32 v107, v23, v91
    v_and_b32 v108, v23, v92
    v_and_b32 v109, v23, v93
    v_and_b32 v110, v23, v94
    v_and_b32 v111, v23, v95
    v_and_b32 v112, v23, v96
    v_and_b32 v113, v23, v97
    v_and_b32 v114, v23, v98
    v_and_b32 v115, v23, v99
    v_and_b32 v116, v23, v100
    v_and_b32 v117, v23, v101
    v_and_b32 v118, v23, v102
    v_and_b32 v119, v23, v103
    v_sub_f32 v104, v88, v104
    v_sub_f32 v105, v89, v105
    v_sub_f32 v106, v90, v106
    v_sub_f32 v107, v91, v107
    v_sub_f32 v108, v92, v108
    v_sub_f32 v109, v93, v109
    v_sub_f32 v110, v94, v110
    v_sub_f32 v111, v95, v111
    v_sub_f32 v112, v96, v112
    v_sub_f32 v113, v97, v113
    v_sub_f32 v114, v98, v114
    v_sub_f32 v115, v99, v115
    v_sub_f32 v116, v100, v116
    v_sub_f32 v117, v101, v117
    v_sub_f32 v118, v102, v118
    v_sub_f32 v119, v103, v119
    v_perm_b32 v168, v105, v104, s43
    v_perm_b32 v169, v107, v106, s43
    v_perm_b32 v170, v109, v108, s43
    v_perm_b32 v171, v111, v110, s43
    v_perm_b32 v172, v113, v112, s43
    v_perm_b32 v173, v115, v114, s43
    v_perm_b32 v174, v117, v116, s43
    v_perm_b32 v175, v119, v118, s43
    s_barrier
    ds_read_b64_tr_b16 v[40:41], v5 offset:0
    ds_read_b64_tr_b16 v[42:43], v5 offset:4096
    ds_read_b64_tr_b16 v[44:45], v6 offset:0
    ds_read_b64_tr_b16 v[46:47], v6 offset:4096
    ds_read_b64_tr_b16 v[48:49], v5 offset:8192
    ds_read_b64_tr_b16 v[50:51], v5 offset:12288
    ds_read_b64_tr_b16 v[52:53], v6 offset:8192
    ds_read_b64_tr_b16 v[54:55], v6 offset:12288
    ds_read_b64_tr_b16 v[184:185], v8 offset:0
    ds_read_b64_tr_b16 v[186:187], v8 offset:2048
    ds_read_b64_tr_b16 v[188:189], v8 offset:4096
    ds_read_b64_tr_b16 v[190:191], v8 offset:6144
    s_waitcnt lgkmcnt(10)
    v_mfma_f32_16x16x32_bf16 v[128:131], v[40:43], v[168:171], v[128:131]
    s_waitcnt lgkmcnt(8)
    v_mfma_f32_16x16x32_bf16 v[132:135], v[44:47], v[168:171], v[132:135]
    s_waitcnt lgkmcnt(6)
    v_mfma_f32_16x16x32_bf16 v[128:131], v[48:51], v[172:175], v[128:131]
    s_waitcnt lgkmcnt(4)
    v_mfma_f32_16x16x32_bf16 v[132:135], v[52:55], v[172:175], v[132:135]
    ds_read_b64_tr_b16 v[192:193], v9 offset:0
    ds_read_b64_tr_b16 v[194:195], v9 offset:2048
    ds_read_b64_tr_b16 v[196:197], v9 offset:4096
    ds_read_b64_tr_b16 v[198:199], v9 offset:6144
    ds_read_b64_tr_b16 v[200:201], v10 offset:0
    ds_read_b64_tr_b16 v[202:203], v10 offset:2048
    ds_read_b64_tr_b16 v[204:205], v10 offset:4096
    ds_read_b64_tr_b16 v[206:207], v10 offset:6144
    s_waitcnt lgkmcnt(8)
    v_mfma_f32_16x16x32_bf16 v[88:91], v[184:187], v[120:123], 0
    v_mfma_f32_16x16x32_bf16 v[88:91], v[188:191], v[124:127], v[88:91]
    ds_read_b64_tr_b16 v[208:209], v11 offset:0
    ds_read_b64_tr_b16 v[210:211], v11 offset:2048
    ds_read_b64_tr_b16 v[212:213], v11 offset:4096
    ds_read_b64_tr_b16 v[214:215], v11 offset:6144
    s_waitcnt lgkmcnt(8)
    v_mfma_f32_16x16x32_bf16 v[92:95], v[192:195], v[120:123], 0
    v_mfma_f32_16x16x32_bf16 v[92:95], v[196:199], v[124:127], v[92:95]
    s_waitcnt lgkmcnt(4)
    v_mfma_f32_16x16x32_bf16 v[96:99], v[200:203], v[120:123], 0
    v_mfma_f32_16x16x32_bf16 v[96:99], v[204:207], v[124:127], v[96:99]
    s_waitcnt lgkmcnt(0)
    v_mfma_f32_16x16x32_bf16 v[100:103], v[208:211], v[120:123], 0
    v_mfma_f32_16x16x32_bf16 v[100:103], v[212:215], v[124:127], v[100:103]
    v_add_u32 v5, s46, v5
    v_add_u32 v6, s46, v6
    v_add_u32 v8, s46, v8
    v_add_u32 v9, s46, v9
    v_add_u32 v10, s46, v10
    v_add_u32 v11, s46, v11
    s_nop 1
    v_and_b32 v104, v23, v88
    v_and_b32 v105, v23, v89
    v_and_b32 v106, v23, v90
    v_and_b32 v107, v23, v91
    v_and_b32 v108, v23, v92
    v_and_b32 v109, v23, v93
    v_and_b32 v110, v23, v94
    v_and_b32 v111, v23, v95
    v_and_b32 v112, v23, v96
    v_and_b32 v113, v23, v97
    v_and_b32 v114, v23, v98
    v_and_b32 v115, v23, v99
    v_and_b32 v116, v23, v100
    v_and_b32 v117, v23, v101
    v_and_b32 v118, v23, v102
    v_and_b32 v119, v23, v103
    v_sub_f32 v104, v88, v104
    v_sub_f32 v105, v89, v105
    v_sub_f32 v106, v90, v106
    v_sub_f32 v107, v91, v107
    v_sub_f32 v108, v92, v108
    v_sub_f32 v109, v93, v109
    v_sub_f32 v110, v94, v110
    v_sub_f32 v111, v95, v111
    v_sub_f32 v112, v96, v112
    v_sub_f32 v113, v97, v113
    v_sub_f32 v114, v98, v114
    v_sub_f32 v115, v99, v115
    v_sub_f32 v116, v100, v116
    v_sub_f32 v117, v101, v117
    v_sub_f32 v118, v102, v118
    v_sub_f32 v119, v103, v119
    v_perm_b32 v176, v105, v104, s43
    v_perm_b32 v177, v107, v106, s43
    v_perm_b32 v178, v109, v108, s43
    v_perm_b32 v179, v111, v110, s43
    v_perm_b32 v180, v113, v112, s43
    v_perm_b32 v181, v115, v114, s43
    v_perm_b32 v182, v117, v116, s43
    v_perm_b32 v183, v119, v118, s43
    ds_read_b64_tr_b16 v[40:41], v5 offset:0
    ds_read_b64_tr_b16 v[42:43], v5 offset:4096
    ds_read_b64_tr_b16 v[44:45], v6 offset:0
    ds_read_b64_tr_b16 v[46:47], v6 offset:4096
    ds_read_b64_tr_b16 v[48:49], v5 offset:8192
    ds_read_b64_tr_b16 v[50:51], v5 offset:12288
    ds_read_b64_tr_b16 v[52:53], v6 offset:8192
    ds_read_b64_tr_b16 v[54:55], v6 offset:12288
    ds_read_b64_tr_b16 v[184:185], v8 offset:0
    ds_read_b64_tr_b16 v[186:187], v8 offset:2048
    ds_read_b64_tr_b16 v[188:189], v8 offset:4096
    ds_read_b64_tr_b16 v[190:191], v8 offset:6144
    s_waitcnt lgkmcnt(10)
    v_mfma_f32_16x16x32_bf16 v[128:131], v[40:43], v[176:179], v[128:131]
    s_waitcnt lgkmcnt(8)
    v_mfma_f32_16x16x32_bf16 v[132:135], v[44:47], v[176:179], v[132:135]
    s_waitcnt lgkmcnt(6)
    v_mfma_f32_16x16x32_bf16 v[128:131], v[48:51], v[180:183], v[128:131]
    s_waitcnt lgkmcnt(4)
    v_mfma_f32_16x16x32_bf16 v[132:135], v[52:55], v[180:183], v[132:135]
    ds_read_b64_tr_b16 v[192:193], v9 offset:0
    ds_read_b64_tr_b16 v[194:195], v9 offset:2048
    ds_read_b64_tr_b16 v[196:197], v9 offset:4096
    ds_read_b64_tr_b16 v[198:199], v9 offset:6144
    ds_read_b64_tr_b16 v[200:201], v10 offset:0
    ds_read_b64_tr_b16 v[202:203], v10 offset:2048
    ds_read_b64_tr_b16 v[204:205], v10 offset:4096
    ds_read_b64_tr_b16 v[206:207], v10 offset:6144
    s_waitcnt lgkmcnt(8)
    v_mfma_f32_16x16x32_bf16 v[88:91], v[184:187], v[120:123], 0
    v_mfma_f32_16x16x32_bf16 v[88:91], v[188:191], v[124:127], v[88:91]
    ds_read_b64_tr_b16 v[208:209], v11 offset:0
    ds_read_b64_tr_b16 v[210:211], v11 offset:2048
    ds_read_b64_tr_b16 v[212:213], v11 offset:4096
    ds_read_b64_tr_b16 v[214:215], v11 offset:6144
    s_waitcnt lgkmcnt(8)
    v_mfma_f32_16x16x32_bf16 v[92:95], v[192:195], v[120:123], 0
    v_mfma_f32_16x16x32_bf16 v[92:95], v[196:199], v[124:127], v[92:95]
    s_waitcnt lgkmcnt(4)
    v_mfma_f32_16x16x32_bf16 v[96:99], v[200:203], v[120:123], 0
    v_mfma_f32_16x16x32_bf16 v[96:99], v[204:207], v[124:127], v[96:99]
    s_waitcnt lgkmcnt(0)
    v_mfma_f32_16x16x32_bf16 v[100:103], v[208:211], v[120:123], 0
    v_mfma_f32_16x16x32_bf16 v[100:103], v[212:215], v[124:127], v[100:103]
    v_add_u32 v5, s47, v5
    v_add_u32 v6, s47, v6
    v_add_u32 v8, s47, v8
    v_add_u32 v9, s47, v9
    v_add_u32 v10, s47, v10
    v_add_u32 v11, s47, v11
    s_nop 1
    v_and_b32 v104, v23, v88
    v_and_b32 v105, v23, v89
    v_and_b32 v106, v23, v90
    v_and_b32 v107, v23, v91
    v_and_b32 v108, v23, v92
    v_and_b32 v109, v23, v93
    v_and_b32 v110, v23, v94
    v_and_b32 v111, v23, v95
    v_and_b32 v112, v23, v96
    v_and_b32 v113, v23, v97
    v_and_b32 v114, v23, v98
    v_and_b32 v115, v23, v99
    v_and_b32 v116, v23, v100
    v_and_b32 v117, v23, v101
    v_and_b32 v118, v23, v102
    v_and_b32 v119, v23, v103
    v_sub_f32 v104, v88, v104
    v_sub_f32 v105, v89, v105
    v_sub_f32 v106, v90, v106
    v_sub_f32 v107, v91, v107
    v_sub_f32 v108, v92, v108
    v_sub_f32 v109, v93, v109
    v_sub_f32 v110, v94, v110
    v_sub_f32 v111, v95, v111
    v_sub_f32 v112, v96, v112
    v_sub_f32 v113, v97, v113
    v_sub_f32 v114, v98, v114
    v_sub_f32 v115, v99, v115
    v_sub_f32 v116, v100, v116
    v_sub_f32 v117, v101, v117
    v_sub_f32 v118, v102, v118
    v_sub_f32 v119, v103, v119
    v_perm_b32 v168, v105, v104, s43
    v_perm_b32 v169, v107, v106, s43
    v_perm_b32 v170, v109, v108, s43
    v_perm_b32 v171, v111, v110, s43
    v_perm_b32 v172, v113, v112, s43
    v_perm_b32 v173, v115, v114, s43
    v_perm_b32 v174, v117, v116, s43
    v_perm_b32 v175, v119, v118, s43
    s_barrier
    ds_read_b64_tr_b16 v[40:41], v5 offset:0
    ds_read_b64_tr_b16 v[42:43], v5 offset:4096
    ds_read_b64_tr_b16 v[44:45], v6 offset:0
    ds_read_b64_tr_b16 v[46:47], v6 offset:4096
    ds_read_b64_tr_b16 v[48:49], v5 offset:8192
    ds_read_b64_tr_b16 v[50:51], v5 offset:12288
    ds_read_b64_tr_b16 v[52:53], v6 offset:8192
    ds_read_b64_tr_b16 v[54:55], v6 offset:12288
    ds_read_b64_tr_b16 v[184:185], v8 offset:0
    ds_read_b64_tr_b16 v[186:187], v8 offset:2048
    ds_read_b64_tr_b16 v[188:189], v8 offset:4096
    ds_read_b64_tr_b16 v[190:191], v8 offset:6144
    s_waitcnt lgkmcnt(10)
    v_mfma_f32_16x16x32_bf16 v[128:131], v[40:43], v[168:171], v[128:131]
    s_waitcnt lgkmcnt(8)
    v_mfma_f32_16x16x32_bf16 v[132:135], v[44:47], v[168:171], v[132:135]
    s_waitcnt lgkmcnt(6)
    v_mfma_f32_16x16x32_bf16 v[128:131], v[48:51], v[172:175], v[128:131]
    s_waitcnt lgkmcnt(4)
    v_mfma_f32_16x16x32_bf16 v[132:135], v[52:55], v[172:175], v[132:135]
    ds_read_b64_tr_b16 v[192:193], v9 offset:0
    ds_read_b64_tr_b16 v[194:195], v9 offset:2048
    ds_read_b64_tr_b16 v[196:197], v9 offset:4096
    ds_read_b64_tr_b16 v[198:199], v9 offset:6144
    ds_read_b64_tr_b16 v[200:201], v10 offset:0
    ds_read_b64_tr_b16 v[202:203], v10 offset:2048
    ds_read_b64_tr_b16 v[204:205], v10 offset:4096
    ds_read_b64_tr_b16 v[206:207], v10 offset:6144
    s_waitcnt lgkmcnt(8)
    v_mfma_f32_16x16x32_bf16 v[88:91], v[184:187], v[120:123], 0
    v_mfma_f32_16x16x32_bf16 v[88:91], v[188:191], v[124:127], v[88:91]
    ds_read_b64_tr_b16 v[208:209], v11 offset:0
    ds_read_b64_tr_b16 v[210:211], v11 offset:2048
    ds_read_b64_tr_b16 v[212:213], v11 offset:4096
    ds_read_b64_tr_b16 v[214:215], v11 offset:6144
    s_waitcnt lgkmcnt(8)
    v_mfma_f32_16x16x32_bf16 v[92:95], v[192:195], v[120:123], 0
    v_mfma_f32_16x16x32_bf16 v[92:95], v[196:199], v[124:127], v[92:95]
    s_waitcnt lgkmcnt(4)
    v_mfma_f32_16x16x32_bf16 v[96:99], v[200:203], v[120:123], 0
    v_mfma_f32_16x16x32_bf16 v[96:99], v[204:207], v[124:127], v[96:99]
    s_waitcnt lgkmcnt(0)
    v_mfma_f32_16x16x32_bf16 v[100:103], v[208:211], v[120:123], 0
    v_mfma_f32_16x16x32_bf16 v[100:103], v[212:215], v[124:127], v[100:103]
    v_add_u32 v5, s46, v5
    v_add_u32 v6, s46, v6
    v_add_u32 v8, s46, v8
    v_add_u32 v9, s46, v9
    v_add_u32 v10, s46, v10
    v_add_u32 v11, s46, v11
    s_nop 1
    v_and_b32 v104, v23, v88
    v_and_b32 v105, v23, v89
    v_and_b32 v106, v23, v90
    v_and_b32 v107, v23, v91
    v_and_b32 v108, v23, v92
    v_and_b32 v109, v23, v93
    v_and_b32 v110, v23, v94
    v_and_b32 v111, v23, v95
    v_and_b32 v112, v23, v96
    v_and_b32 v113, v23, v97
    v_and_b32 v114, v23, v98
    v_and_b32 v115, v23, v99
    v_and_b32 v116, v23, v100
    v_and_b32 v117, v23, v101
    v_and_b32 v118, v23, v102
    v_and_b32 v119, v23, v103
    v_sub_f32 v104, v88, v104
    v_sub_f32 v105, v89, v105
    v_sub_f32 v106, v90, v106
    v_sub_f32 v107, v91, v107
    v_sub_f32 v108, v92, v108
    v_sub_f32 v109, v93, v109
    v_sub_f32 v110, v94, v110
    v_sub_f32 v111, v95, v111
    v_sub_f32 v112, v96, v112
    v_sub_f32 v113, v97, v113
    v_sub_f32 v114, v98, v114
    v_sub_f32 v115, v99, v115
    v_sub_f32 v116, v100, v116
    v_sub_f32 v117, v101, v117
    v_sub_f32 v118, v102, v118
    v_sub_f32 v119, v103, v119
    v_perm_b32 v176, v105, v104, s43
    v_perm_b32 v177, v107, v106, s43
    v_perm_b32 v178, v109, v108, s43
    v_perm_b32 v179, v111, v110, s43
    v_perm_b32 v180, v113, v112, s43
    v_perm_b32 v181, v115, v114, s43
    v_perm_b32 v182, v117, v116, s43
    v_perm_b32 v183, v119, v118, s43
    s_barrier
    ds_read_b64_tr_b16 v[40:41], v5 offset:0
    ds_read_b64_tr_b16 v[42:43], v5 offset:4096
    ds_read_b64_tr_b16 v[44:45], v6 offset:0
    ds_read_b64_tr_b16 v[46:47], v6 offset:4096
    ds_read_b64_tr_b16 v[48:49], v5 offset:8192
    ds_read_b64_tr_b16 v[50:51], v5 offset:12288
    ds_read_b64_tr_b16 v[52:53], v6 offset:8192
    ds_read_b64_tr_b16 v[54:55], v6 offset:12288
    ds_read_b64_tr_b16 v[184:185], v8 offset:0
    ds_read_b64_tr_b16 v[186:187], v8 offset:2048
    ds_read_b64_tr_b16 v[188:189], v8 offset:4096
    ds_read_b64_tr_b16 v[190:191], v8 offset:6144
    s_waitcnt lgkmcnt(10)
    v_mfma_f32_16x16x32_bf16 v[128:131], v[40:43], v[176:179], v[128:131]
    s_waitcnt lgkmcnt(8)
    v_mfma_f32_16x16x32_bf16 v[132:135], v[44:47], v[176:179], v[132:135]
    s_waitcnt lgkmcnt(6)
    v_mfma_f32_16x16x32_bf16 v[128:131], v[48:51], v[180:183], v[128:131]
    s_waitcnt lgkmcnt(4)
    v_mfma_f32_16x16x32_bf16 v[132:135], v[52:55], v[180:183], v[132:135]
    ds_read_b64_tr_b16 v[192:193], v9 offset:0
    ds_read_b64_tr_b16 v[194:195], v9 offset:2048
    ds_read_b64_tr_b16 v[196:197], v9 offset:4096
    ds_read_b64_tr_b16 v[198:199], v9 offset:6144
    ds_read_b64_tr_b16 v[200:201], v10 offset:0
    ds_read_b64_tr_b16 v[202:203], v10 offset:2048
    ds_read_b64_tr_b16 v[204:205], v10 offset:4096
    ds_read_b64_tr_b16 v[206:207], v10 offset:6144
    s_waitcnt lgkmcnt(8)
    v_mfma_f32_16x16x32_bf16 v[88:91], v[184:187], v[120:123], 0
    v_mfma_f32_16x16x32_bf16 v[88:91], v[188:191], v[124:127], v[88:91]
    ds_read_b64_tr_b16 v[208:209], v11 offset:0
    ds_read_b64_tr_b16 v[210:211], v11 offset:2048
    ds_read_b64_tr_b16 v[212:213], v11 offset:4096
    ds_read_b64_tr_b16 v[214:215], v11 offset:6144
    s_waitcnt lgkmcnt(8)
    v_mfma_f32_16x16x32_bf16 v[92:95], v[192:195], v[120:123], 0
    v_mfma_f32_16x16x32_bf16 v[92:95], v[196:199], v[124:127], v[92:95]
    s_waitcnt lgkmcnt(4)
    v_mfma_f32_16x16x32_bf16 v[96:99], v[200:203], v[120:123], 0
    v_mfma_f32_16x16x32_bf16 v[96:99], v[204:207], v[124:127], v[96:99]
    s_waitcnt lgkmcnt(0)
    v_mfma_f32_16x16x32_bf16 v[100:103], v[208:211], v[120:123], 0
    v_mfma_f32_16x16x32_bf16 v[100:103], v[212:215], v[124:127], v[100:103]
    v_add_u32 v5, s46, v5
    v_add_u32 v6, s46, v6
    v_add_u32 v8, s46, v8
    v_add_u32 v9, s46, v9
    v_add_u32 v10, s46, v10
    v_add_u32 v11, s46, v11
    s_nop 1
    v_and_b32 v104, v23, v88
    v_and_b32 v105, v23, v89
    v_and_b32 v106, v23, v90
    v_and_b32 v107, v23, v91
    v_and_b32 v108, v23, v92
    v_and_b32 v109, v23, v93
    v_and_b32 v110, v23, v94
    v_and_b32 v111, v23, v95
    v_and_b32 v112, v23, v96
    v_and_b32 v113, v23, v97
    v_and_b32 v114, v23, v98
    v_and_b32 v115, v23, v99
    v_and_b32 v116, v23, v100
    v_and_b32 v117, v23, v101
    v_and_b32 v118, v23, v102
    v_and_b32 v119, v23, v103
    v_sub_f32 v104, v88, v104
    v_sub_f32 v105, v89, v105
    v_sub_f32 v106, v90, v106
    v_sub_f32 v107, v91, v107
    v_sub_f32 v108, v92, v108
    v_sub_f32 v109, v93, v109
    v_sub_f32 v110, v94, v110
    v_sub_f32 v111, v95, v111
    v_sub_f32 v112, v96, v112
    v_sub_f32 v113, v97, v113
    v_sub_f32 v114, v98, v114
    v_sub_f32 v115, v99, v115
    v_sub_f32 v116, v100, v116
    v_sub_f32 v117, v101, v117
    v_sub_f32 v118, v102, v118
    v_sub_f32 v119, v103, v119
    v_perm_b32 v168, v105, v104, s43
    v_perm_b32 v169, v107, v106, s43
    v_perm_b32 v170, v109, v108, s43
    v_perm_b32 v171, v111, v110, s43
    v_perm_b32 v172, v113, v112, s43
    v_perm_b32 v173, v115, v114, s43
    v_perm_b32 v174, v117, v116, s43
    v_perm_b32 v175, v119, v118, s43
    s_barrier
    ds_read_b64_tr_b16 v[40:41], v5 offset:0
    ds_read_b64_tr_b16 v[42:43], v5 offset:4096
    ds_read_b64_tr_b16 v[44:45], v6 offset:0
    ds_read_b64_tr_b16 v[46:47], v6 offset:4096
    ds_read_b64_tr_b16 v[48:49], v5 offset:8192
    ds_read_b64_tr_b16 v[50:51], v5 offset:12288
    ds_read_b64_tr_b16 v[52:53], v6 offset:8192
    ds_read_b64_tr_b16 v[54:55], v6 offset:12288
    ds_read_b64_tr_b16 v[184:185], v8 offset:0
    ds_read_b64_tr_b16 v[186:187], v8 offset:2048
    ds_read_b64_tr_b16 v[188:189], v8 offset:4096
    ds_read_b64_tr_b16 v[190:191], v8 offset:6144
    s_waitcnt lgkmcnt(10)
    v_mfma_f32_16x16x32_bf16 v[128:131], v[40:43], v[168:171], v[128:131]
    s_waitcnt lgkmcnt(8)
    v_mfma_f32_16x16x32_bf16 v[132:135], v[44:47], v[168:171], v[132:135]
    s_waitcnt lgkmcnt(6)
    v_mfma_f32_16x16x32_bf16 v[128:131], v[48:51], v[172:175], v[128:131]
    s_waitcnt lgkmcnt(4)
    v_mfma_f32_16x16x32_bf16 v[132:135], v[52:55], v[172:175], v[132:135]
    ds_read_b64_tr_b16 v[192:193], v9 offset:0
    ds_read_b64_tr_b16 v[194:195], v9 offset:2048
    ds_read_b64_tr_b16 v[196:197], v9 offset:4096
    ds_read_b64_tr_b16 v[198:199], v9 offset:6144
    ds_read_b64_tr_b16 v[200:201], v10 offset:0
    ds_read_b64_tr_b16 v[202:203], v10 offset:2048
    ds_read_b64_tr_b16 v[204:205], v10 offset:4096
    ds_read_b64_tr_b16 v[206:207], v10 offset:6144
    s_waitcnt lgkmcnt(8)
    v_mfma_f32_16x16x32_bf16 v[88:91], v[184:187], v[120:123], 0
    v_mfma_f32_16x16x32_bf16 v[88:91], v[188:191], v[124:127], v[88:91]
    ds_read_b64_tr_b16 v[208:209], v11 offset:0
    ds_read_b64_tr_b16 v[210:211], v11 offset:2048
    ds_read_b64_tr_b16 v[212:213], v11 offset:4096
    ds_read_b64_tr_b16 v[214:215], v11 offset:6144
    s_waitcnt lgkmcnt(8)
    v_mfma_f32_16x16x32_bf16 v[92:95], v[192:195], v[120:123], 0
    v_mfma_f32_16x16x32_bf16 v[92:95], v[196:199], v[124:127], v[92:95]
    s_waitcnt lgkmcnt(4)
    v_mfma_f32_16x16x32_bf16 v[96:99], v[200:203], v[120:123], 0
    v_mfma_f32_16x16x32_bf16 v[96:99], v[204:207], v[124:127], v[96:99]
    s_waitcnt lgkmcnt(0)
    v_mfma_f32_16x16x32_bf16 v[100:103], v[208:211], v[120:123], 0
    v_mfma_f32_16x16x32_bf16 v[100:103], v[212:215], v[124:127], v[100:103]
    v_add_u32 v5, s46, v5
    v_add_u32 v6, s46, v6
    v_add_u32 v8, s46, v8
    v_add_u32 v9, s46, v9
    v_add_u32 v10, s46, v10
    v_add_u32 v11, s46, v11
    s_nop 1
    v_and_b32 v104, v23, v88
    v_and_b32 v105, v23, v89
    v_and_b32 v106, v23, v90
    v_and_b32 v107, v23, v91
    v_and_b32 v108, v23, v92
    v_and_b32 v109, v23, v93
    v_and_b32 v110, v23, v94
    v_and_b32 v111, v23, v95
    v_and_b32 v112, v23, v96
    v_and_b32 v113, v23, v97
    v_and_b32 v114, v23, v98
    v_and_b32 v115, v23, v99
    v_and_b32 v116, v23, v100
    v_and_b32 v117, v23, v101
    v_and_b32 v118, v23, v102
    v_and_b32 v119, v23, v103
    v_sub_f32 v104, v88, v104
    v_sub_f32 v105, v89, v105
    v_sub_f32 v106, v90, v106
    v_sub_f32 v107, v91, v107
    v_sub_f32 v108, v92, v108
    v_sub_f32 v109, v93, v109
    v_sub_f32 v110, v94, v110
    v_sub_f32 v111, v95, v111
    v_sub_f32 v112, v96, v112
    v_sub_f32 v113, v97, v113
    v_sub_f32 v114, v98, v114
    v_sub_f32 v115, v99, v115
    v_sub_f32 v116, v100, v116
    v_sub_f32 v117, v101, v117
    v_sub_f32 v118, v102, v118
    v_sub_f32 v119, v103, v119
    v_perm_b32 v176, v105, v104, s43
    v_perm_b32 v177, v107, v106, s43
    v_perm_b32 v178, v109, v108, s43
    v_perm_b32 v179, v111, v110, s43
    v_perm_b32 v180, v113, v112, s43
    v_perm_b32 v181, v115, v114, s43
    v_perm_b32 v182, v117, v116, s43
    v_perm_b32 v183, v119, v118, s43
    s_barrier
    ds_read_b64_tr_b16 v[40:41], v5 offset:0
    ds_read_b64_tr_b16 v[42:43], v5 offset:4096
    ds_read_b64_tr_b16 v[44:45], v6 offset:0
    ds_read_b64_tr_b16 v[46:47], v6 offset:4096
    ds_read_b64_tr_b16 v[48:49], v5 offset:8192
    ds_read_b64_tr_b16 v[50:51], v5 offset:12288
    ds_read_b64_tr_b16 v[52:53], v6 offset:8192
    ds_read_b64_tr_b16 v[54:55], v6 offset:12288
    ds_read_b64_tr_b16 v[184:185], v8 offset:0
    ds_read_b64_tr_b16 v[186:187], v8 offset:2048
    ds_read_b64_tr_b16 v[188:189], v8 offset:4096
    ds_read_b64_tr_b16 v[190:191], v8 offset:6144
    s_waitcnt lgkmcnt(10)
    v_mfma_f32_16x16x32_bf16 v[128:131], v[40:43], v[176:179], v[128:131]
    s_waitcnt lgkmcnt(8)
    v_mfma_f32_16x16x32_bf16 v[132:135], v[44:47], v[176:179], v[132:135]
    s_waitcnt lgkmcnt(6)
    v_mfma_f32_16x16x32_bf16 v[128:131], v[48:51], v[180:183], v[128:131]
    s_waitcnt lgkmcnt(4)
    v_mfma_f32_16x16x32_bf16 v[132:135], v[52:55], v[180:183], v[132:135]
    ds_read_b64_tr_b16 v[192:193], v9 offset:0
    ds_read_b64_tr_b16 v[194:195], v9 offset:2048
    ds_read_b64_tr_b16 v[196:197], v9 offset:4096
    ds_read_b64_tr_b16 v[198:199], v9 offset:6144
    ds_read_b64_tr_b16 v[200:201], v10 offset:0
    ds_read_b64_tr_b16 v[202:203], v10 offset:2048
    ds_read_b64_tr_b16 v[204:205], v10 offset:4096
    ds_read_b64_tr_b16 v[206:207], v10 offset:6144
    s_waitcnt lgkmcnt(8)
    v_mfma_f32_16x16x32_bf16 v[88:91], v[184:187], v[120:123], 0
    v_mfma_f32_16x16x32_bf16 v[88:91], v[188:191], v[124:127], v[88:91]
    ds_read_b64_tr_b16 v[208:209], v11 offset:0
    ds_read_b64_tr_b16 v[210:211], v11 offset:2048
    ds_read_b64_tr_b16 v[212:213], v11 offset:4096
    ds_read_b64_tr_b16 v[214:215], v11 offset:6144
    s_waitcnt lgkmcnt(8)
    v_mfma_f32_16x16x32_bf16 v[92:95], v[192:195], v[120:123], 0
    v_mfma_f32_16x16x32_bf16 v[92:95], v[196:199], v[124:127], v[92:95]
    s_waitcnt lgkmcnt(4)
    v_mfma_f32_16x16x32_bf16 v[96:99], v[200:203], v[120:123], 0
    v_mfma_f32_16x16x32_bf16 v[96:99], v[204:207], v[124:127], v[96:99]
    s_waitcnt lgkmcnt(0)
    v_mfma_f32_16x16x32_bf16 v[100:103], v[208:211], v[120:123], 0
    v_mfma_f32_16x16x32_bf16 v[100:103], v[212:215], v[124:127], v[100:103]
    v_add_u32 v5, s46, v5
    v_add_u32 v6, s46, v6
    v_add_u32 v8, s46, v8
    v_add_u32 v9, s46, v9
    v_add_u32 v10, s46, v10
    v_add_u32 v11, s46, v11
    s_nop 1
    v_and_b32 v104, v23, v88
    v_and_b32 v105, v23, v89
    v_and_b32 v106, v23, v90
    v_and_b32 v107, v23, v91
    v_and_b32 v108, v23, v92
    v_and_b32 v109, v23, v93
    v_and_b32 v110, v23, v94
    v_and_b32 v111, v23, v95
    v_and_b32 v112, v23, v96
    v_and_b32 v113, v23, v97
    v_and_b32 v114, v23, v98
    v_and_b32 v115, v23, v99
    v_and_b32 v116, v23, v100
    v_and_b32 v117, v23, v101
    v_and_b32 v118, v23, v102
    v_and_b32 v119, v23, v103
    v_sub_f32 v104, v88, v104
    v_sub_f32 v105, v89, v105
    v_sub_f32 v106, v90, v106
    v_sub_f32 v107, v91, v107
    v_sub_f32 v108, v92, v108
    v_sub_f32 v109, v93, v109
    v_sub_f32 v110, v94, v110
    v_sub_f32 v111, v95, v111
    v_sub_f32 v112, v96, v112
    v_sub_f32 v113, v97, v113
    v_sub_f32 v114, v98, v114
    v_sub_f32 v115, v99, v115
    v_sub_f32 v116, v100, v116
    v_sub_f32 v117, v101, v117
    v_sub_f32 v118, v102, v118
    v_sub_f32 v119, v103, v119
    v_perm_b32 v168, v105, v104, s43
    v_perm_b32 v169, v107, v106, s43
    v_perm_b32 v170, v109, v108, s43
    v_perm_b32 v171, v111, v110, s43
    v_perm_b32 v172, v113, v112, s43
    v_perm_b32 v173, v115, v114, s43
    v_perm_b32 v174, v117, v116, s43
    v_perm_b32 v175, v119, v118, s43
    s_barrier
    ds_read_b64_tr_b16 v[40:41], v5 offset:0
    ds_read_b64_tr_b16 v[42:43], v5 offset:4096
    ds_read_b64_tr_b16 v[44:45], v6 offset:0
    ds_read_b64_tr_b16 v[46:47], v6 offset:4096
    ds_read_b64_tr_b16 v[48:49], v5 offset:8192
    ds_read_b64_tr_b16 v[50:51], v5 offset:12288
    ds_read_b64_tr_b16 v[52:53], v6 offset:8192
    ds_read_b64_tr_b16 v[54:55], v6 offset:12288
    ds_read_b64_tr_b16 v[184:185], v8 offset:0
    ds_read_b64_tr_b16 v[186:187], v8 offset:2048
    ds_read_b64_tr_b16 v[188:189], v8 offset:4096
    ds_read_b64_tr_b16 v[190:191], v8 offset:6144
    s_waitcnt lgkmcnt(10)
    v_mfma_f32_16x16x32_bf16 v[128:131], v[40:43], v[168:171], v[128:131]
    s_waitcnt lgkmcnt(8)
    v_mfma_f32_16x16x32_bf16 v[132:135], v[44:47], v[168:171], v[132:135]
    s_waitcnt lgkmcnt(6)
    v_mfma_f32_16x16x32_bf16 v[128:131], v[48:51], v[172:175], v[128:131]
    s_waitcnt lgkmcnt(4)
    v_mfma_f32_16x16x32_bf16 v[132:135], v[52:55], v[172:175], v[132:135]
    ds_read_b64_tr_b16 v[192:193], v9 offset:0
    ds_read_b64_tr_b16 v[194:195], v9 offset:2048
    ds_read_b64_tr_b16 v[196:197], v9 offset:4096
    ds_read_b64_tr_b16 v[198:199], v9 offset:6144
    ds_read_b64_tr_b16 v[200:201], v10 offset:0
    ds_read_b64_tr_b16 v[202:203], v10 offset:2048
    ds_read_b64_tr_b16 v[204:205], v10 offset:4096
    ds_read_b64_tr_b16 v[206:207], v10 offset:6144
    s_waitcnt lgkmcnt(8)
    v_mfma_f32_16x16x32_bf16 v[88:91], v[184:187], v[120:123], 0
    v_mfma_f32_16x16x32_bf16 v[88:91], v[188:191], v[124:127], v[88:91]
    ds_read_b64_tr_b16 v[208:209], v11 offset:0
    ds_read_b64_tr_b16 v[210:211], v11 offset:2048
    ds_read_b64_tr_b16 v[212:213], v11 offset:4096
    ds_read_b64_tr_b16 v[214:215], v11 offset:6144
    s_waitcnt lgkmcnt(8)
    v_mfma_f32_16x16x32_bf16 v[92:95], v[192:195], v[120:123], 0
    v_mfma_f32_16x16x32_bf16 v[92:95], v[196:199], v[124:127], v[92:95]
    s_waitcnt lgkmcnt(4)
    v_mfma_f32_16x16x32_bf16 v[96:99], v[200:203], v[120:123], 0
    v_mfma_f32_16x16x32_bf16 v[96:99], v[204:207], v[124:127], v[96:99]
    s_waitcnt lgkmcnt(0)
    v_mfma_f32_16x16x32_bf16 v[100:103], v[208:211], v[120:123], 0
    v_mfma_f32_16x16x32_bf16 v[100:103], v[212:215], v[124:127], v[100:103]
    v_add_u32 v5, s46, v5
    v_add_u32 v6, s46, v6
    v_add_u32 v8, s46, v8
    v_add_u32 v9, s46, v9
    v_add_u32 v10, s46, v10
    v_add_u32 v11, s46, v11
    s_nop 1
    v_and_b32 v104, v23, v88
    v_and_b32 v105, v23, v89
    v_and_b32 v106, v23, v90
    v_and_b32 v107, v23, v91
    v_and_b32 v108, v23, v92
    v_and_b32 v109, v23, v93
    v_and_b32 v110, v23, v94
    v_and_b32 v111, v23, v95
    v_and_b32 v112, v23, v96
    v_and_b32 v113, v23, v97
    v_and_b32 v114, v23, v98
    v_and_b32 v115, v23, v99
    v_and_b32 v116, v23, v100
    v_and_b32 v117, v23, v101
    v_and_b32 v118, v23, v102
    v_and_b32 v119, v23, v103
    v_sub_f32 v104, v88, v104
    v_sub_f32 v105, v89, v105
    v_sub_f32 v106, v90, v106
    v_sub_f32 v107, v91, v107
    v_sub_f32 v108, v92, v108
    v_sub_f32 v109, v93, v109
    v_sub_f32 v110, v94, v110
    v_sub_f32 v111, v95, v111
    v_sub_f32 v112, v96, v112
    v_sub_f32 v113, v97, v113
    v_sub_f32 v114, v98, v114
    v_sub_f32 v115, v99, v115
    v_sub_f32 v116, v100, v116
    v_sub_f32 v117, v101, v117
    v_sub_f32 v118, v102, v118
    v_sub_f32 v119, v103, v119
    v_perm_b32 v176, v105, v104, s43
    v_perm_b32 v177, v107, v106, s43
    v_perm_b32 v178, v109, v108, s43
    v_perm_b32 v179, v111, v110, s43
    v_perm_b32 v180, v113, v112, s43
    v_perm_b32 v181, v115, v114, s43
    v_perm_b32 v182, v117, v116, s43
    v_perm_b32 v183, v119, v118, s43
    s_barrier
    ds_read_b64_tr_b16 v[40:41], v5 offset:0
    ds_read_b64_tr_b16 v[42:43], v5 offset:4096
    ds_read_b64_tr_b16 v[44:45], v6 offset:0
    ds_read_b64_tr_b16 v[46:47], v6 offset:4096
    ds_read_b64_tr_b16 v[48:49], v5 offset:8192
    ds_read_b64_tr_b16 v[50:51], v5 offset:12288
    ds_read_b64_tr_b16 v[52:53], v6 offset:8192
    ds_read_b64_tr_b16 v[54:55], v6 offset:12288
    ds_read_b64_tr_b16 v[184:185], v8 offset:0
    ds_read_b64_tr_b16 v[186:187], v8 offset:2048
    ds_read_b64_tr_b16 v[188:189], v8 offset:4096
    ds_read_b64_tr_b16 v[190:191], v8 offset:6144
    s_waitcnt lgkmcnt(10)
    v_mfma_f32_16x16x32_bf16 v[128:131], v[40:43], v[176:179], v[128:131]
    s_waitcnt lgkmcnt(8)
    v_mfma_f32_16x16x32_bf16 v[132:135], v[44:47], v[176:179], v[132:135]
    s_waitcnt lgkmcnt(6)
    v_mfma_f32_16x16x32_bf16 v[128:131], v[48:51], v[180:183], v[128:131]
    s_waitcnt lgkmcnt(4)
    v_mfma_f32_16x16x32_bf16 v[132:135], v[52:55], v[180:183], v[132:135]
    ds_read_b64_tr_b16 v[192:193], v9 offset:0
    ds_read_b64_tr_b16 v[194:195], v9 offset:2048
    ds_read_b64_tr_b16 v[196:197], v9 offset:4096
    ds_read_b64_tr_b16 v[198:199], v9 offset:6144
    ds_read_b64_tr_b16 v[200:201], v10 offset:0
    ds_read_b64_tr_b16 v[202:203], v10 offset:2048
    ds_read_b64_tr_b16 v[204:205], v10 offset:4096
    ds_read_b64_tr_b16 v[206:207], v10 offset:6144
    s_waitcnt lgkmcnt(8)
    v_mfma_f32_16x16x32_bf16 v[88:91], v[184:187], v[120:123], 0
    v_mfma_f32_16x16x32_bf16 v[88:91], v[188:191], v[124:127], v[88:91]
    ds_read_b64_tr_b16 v[208:209], v11 offset:0
    ds_read_b64_tr_b16 v[210:211], v11 offset:2048
    ds_read_b64_tr_b16 v[212:213], v11 offset:4096
    ds_read_b64_tr_b16 v[214:215], v11 offset:6144
    s_waitcnt lgkmcnt(8)
    v_mfma_f32_16x16x32_bf16 v[92:95], v[192:195], v[120:123], 0
    v_mfma_f32_16x16x32_bf16 v[92:95], v[196:199], v[124:127], v[92:95]
    s_waitcnt lgkmcnt(4)
    v_mfma_f32_16x16x32_bf16 v[96:99], v[200:203], v[120:123], 0
    v_mfma_f32_16x16x32_bf16 v[96:99], v[204:207], v[124:127], v[96:99]
    s_waitcnt lgkmcnt(0)
    v_mfma_f32_16x16x32_bf16 v[100:103], v[208:211], v[120:123], 0
    v_mfma_f32_16x16x32_bf16 v[100:103], v[212:215], v[124:127], v[100:103]
    v_add_u32 v5, s47, v5
    v_add_u32 v6, s47, v6
    v_add_u32 v8, s47, v8
    v_add_u32 v9, s47, v9
    v_add_u32 v10, s47, v10
    v_add_u32 v11, s47, v11
    s_nop 1
    v_and_b32 v104, v23, v88
    v_and_b32 v105, v23, v89
    v_and_b32 v106, v23, v90
    v_and_b32 v107, v23, v91
    v_and_b32 v108, v23, v92
    v_and_b32 v109, v23, v93
    v_and_b32 v110, v23, v94
    v_and_b32 v111, v23, v95
    v_and_b32 v112, v23, v96
    v_and_b32 v113, v23, v97
    v_and_b32 v114, v23, v98
    v_and_b32 v115, v23, v99
    v_and_b32 v116, v23, v100
    v_and_b32 v117, v23, v101
    v_and_b32 v118, v23, v102
    v_and_b32 v119, v23, v103
    v_sub_f32 v104, v88, v104
    v_sub_f32 v105, v89, v105
    v_sub_f32 v106, v90, v106
    v_sub_f32 v107, v91, v107
    v_sub_f32 v108, v92, v108
    v_sub_f32 v109, v93, v109
    v_sub_f32 v110, v94, v110
    v_sub_f32 v111, v95, v111
    v_sub_f32 v112, v96, v112
    v_sub_f32 v113, v97, v113
    v_sub_f32 v114, v98, v114
    v_sub_f32 v115, v99, v115
    v_sub_f32 v116, v100, v116
    v_sub_f32 v117, v101, v117
    v_sub_f32 v118, v102, v118
    v_sub_f32 v119, v103, v119
    v_perm_b32 v168, v105, v104, s43
    v_perm_b32 v169, v107, v106, s43
    v_perm_b32 v170, v109, v108, s43
    v_perm_b32 v171, v111, v110, s43
    v_perm_b32 v172, v113, v112, s43
    v_perm_b32 v173, v115, v114, s43
    v_perm_b32 v174, v117, v116, s43
    v_perm_b32 v175, v119, v118, s43
    s_barrier
    ds_read_b64_tr_b16 v[40:41], v5 offset:0
    ds_read_b64_tr_b16 v[42:43], v5 offset:4096
    ds_read_b64_tr_b16 v[44:45], v6 offset:0
    ds_read_b64_tr_b16 v[46:47], v6 offset:4096
    ds_read_b64_tr_b16 v[48:49], v5 offset:8192
    ds_read_b64_tr_b16 v[50:51], v5 offset:12288
    ds_read_b64_tr_b16 v[52:53], v6 offset:8192
    ds_read_b64_tr_b16 v[54:55], v6 offset:12288
    ds_read_b64_tr_b16 v[184:185], v8 offset:0
    ds_read_b64_tr_b16 v[186:187], v8 offset:2048
    ds_read_b64_tr_b16 v[188:189], v8 offset:4096
    ds_read_b64_tr_b16 v[190:191], v8 offset:6144
    s_waitcnt lgkmcnt(10)
    v_mfma_f32_16x16x32_bf16 v[128:131], v[40:43], v[168:171], v[128:131]
    s_waitcnt lgkmcnt(8)
    v_mfma_f32_16x16x32_bf16 v[132:135], v[44:47], v[168:171], v[132:135]
    s_waitcnt lgkmcnt(6)
    v_mfma_f32_16x16x32_bf16 v[128:131], v[48:51], v[172:175], v[128:131]
    s_waitcnt lgkmcnt(4)
    v_mfma_f32_16x16x32_bf16 v[132:135], v[52:55], v[172:175], v[132:135]
    ds_read_b64_tr_b16 v[192:193], v9 offset:0
    ds_read_b64_tr_b16 v[194:195], v9 offset:2048
    ds_read_b64_tr_b16 v[196:197], v9 offset:4096
    ds_read_b64_tr_b16 v[198:199], v9 offset:6144
    ds_read_b64_tr_b16 v[200:201], v10 offset:0
    ds_read_b64_tr_b16 v[202:203], v10 offset:2048
    ds_read_b64_tr_b16 v[204:205], v10 offset:4096
    ds_read_b64_tr_b16 v[206:207], v10 offset:6144
    s_waitcnt lgkmcnt(8)
    v_mfma_f32_16x16x32_bf16 v[88:91], v[184:187], v[120:123], 0
    v_mfma_f32_16x16x32_bf16 v[88:91], v[188:191], v[124:127], v[88:91]
    ds_read_b64_tr_b16 v[208:209], v11 offset:0
    ds_read_b64_tr_b16 v[210:211], v11 offset:2048
    ds_read_b64_tr_b16 v[212:213], v11 offset:4096
    ds_read_b64_tr_b16 v[214:215], v11 offset:6144
    s_waitcnt lgkmcnt(8)
    v_mfma_f32_16x16x32_bf16 v[92:95], v[192:195], v[120:123], 0
    v_mfma_f32_16x16x32_bf16 v[92:95], v[196:199], v[124:127], v[92:95]
    s_waitcnt lgkmcnt(4)
    v_mfma_f32_16x16x32_bf16 v[96:99], v[200:203], v[120:123], 0
    v_mfma_f32_16x16x32_bf16 v[96:99], v[204:207], v[124:127], v[96:99]
    s_waitcnt lgkmcnt(0)
    v_mfma_f32_16x16x32_bf16 v[100:103], v[208:211], v[120:123], 0
    v_mfma_f32_16x16x32_bf16 v[100:103], v[212:215], v[124:127], v[100:103]
    v_add_u32 v5, s46, v5
    v_add_u32 v6, s46, v6
    v_add_u32 v8, s46, v8
    v_add_u32 v9, s46, v9
    v_add_u32 v10, s46, v10
    v_add_u32 v11, s46, v11
    s_nop 1
    v_and_b32 v104, v23, v88
    v_and_b32 v105, v23, v89
    v_and_b32 v106, v23, v90
    v_and_b32 v107, v23, v91
    v_and_b32 v108, v23, v92
    v_and_b32 v109, v23, v93
    v_and_b32 v110, v23, v94
    v_and_b32 v111, v23, v95
    v_and_b32 v112, v23, v96
    v_and_b32 v113, v23, v97
    v_and_b32 v114, v23, v98
    v_and_b32 v115, v23, v99
    v_and_b32 v116, v23, v100
    v_and_b32 v117, v23, v101
    v_and_b32 v118, v23, v102
    v_and_b32 v119, v23, v103
    v_sub_f32 v104, v88, v104
    v_sub_f32 v105, v89, v105
    v_sub_f32 v106, v90, v106
    v_sub_f32 v107, v91, v107
    v_sub_f32 v108, v92, v108
    v_sub_f32 v109, v93, v109
    v_sub_f32 v110, v94, v110
    v_sub_f32 v111, v95, v111
    v_sub_f32 v112, v96, v112
    v_sub_f32 v113, v97, v113
    v_sub_f32 v114, v98, v114
    v_sub_f32 v115, v99, v115
    v_sub_f32 v116, v100, v116
    v_sub_f32 v117, v101, v117
    v_sub_f32 v118, v102, v118
    v_sub_f32 v119, v103, v119
    v_perm_b32 v176, v105, v104, s43
    v_perm_b32 v177, v107, v106, s43
    v_perm_b32 v178, v109, v108, s43
    v_perm_b32 v179, v111, v110, s43
    v_perm_b32 v180, v113, v112, s43
    v_perm_b32 v181, v115, v114, s43
    v_perm_b32 v182, v117, v116, s43
    v_perm_b32 v183, v119, v118, s43
    s_barrier
    ds_read_b64_tr_b16 v[40:41], v5 offset:0
    ds_read_b64_tr_b16 v[42:43], v5 offset:4096
    ds_read_b64_tr_b16 v[44:45], v6 offset:0
    ds_read_b64_tr_b16 v[46:47], v6 offset:4096
    ds_read_b64_tr_b16 v[48:49], v5 offset:8192
    ds_read_b64_tr_b16 v[50:51], v5 offset:12288
    ds_read_b64_tr_b16 v[52:53], v6 offset:8192
    ds_read_b64_tr_b16 v[54:55], v6 offset:12288
    ds_read_b64_tr_b16 v[184:185], v8 offset:0
    ds_read_b64_tr_b16 v[186:187], v8 offset:2048
    ds_read_b64_tr_b16 v[188:189], v8 offset:4096
    ds_read_b64_tr_b16 v[190:191], v8 offset:6144
    s_waitcnt lgkmcnt(10)
    v_mfma_f32_16x16x32_bf16 v[128:131], v[40:43], v[176:179], v[128:131]
    s_waitcnt lgkmcnt(8)
    v_mfma_f32_16x16x32_bf16 v[132:135], v[44:47], v[176:179], v[132:135]
    s_waitcnt lgkmcnt(6)
    v_mfma_f32_16x16x32_bf16 v[128:131], v[48:51], v[180:183], v[128:131]
    s_waitcnt lgkmcnt(4)
    v_mfma_f32_16x16x32_bf16 v[132:135], v[52:55], v[180:183], v[132:135]
    ds_read_b64_tr_b16 v[192:193], v9 offset:0
    ds_read_b64_tr_b16 v[194:195], v9 offset:2048
    ds_read_b64_tr_b16 v[196:197], v9 offset:4096
    ds_read_b64_tr_b16 v[198:199], v9 offset:6144
    ds_read_b64_tr_b16 v[200:201], v10 offset:0
    ds_read_b64_tr_b16 v[202:203], v10 offset:2048
    ds_read_b64_tr_b16 v[204:205], v10 offset:4096
    ds_read_b64_tr_b16 v[206:207], v10 offset:6144
    s_waitcnt lgkmcnt(8)
    v_mfma_f32_16x16x32_bf16 v[88:91], v[184:187], v[120:123], 0
    v_mfma_f32_16x16x32_bf16 v[88:91], v[188:191], v[124:127], v[88:91]
    ds_read_b64_tr_b16 v[208:209], v11 offset:0
    ds_read_b64_tr_b16 v[210:211], v11 offset:2048
    ds_read_b64_tr_b16 v[212:213], v11 offset:4096
    ds_read_b64_tr_b16 v[214:215], v11 offset:6144
    s_waitcnt lgkmcnt(8)
    v_mfma_f32_16x16x32_bf16 v[92:95], v[192:195], v[120:123], 0
    v_mfma_f32_16x16x32_bf16 v[92:95], v[196:199], v[124:127], v[92:95]
    s_waitcnt lgkmcnt(4)
    v_mfma_f32_16x16x32_bf16 v[96:99], v[200:203], v[120:123], 0
    v_mfma_f32_16x16x32_bf16 v[96:99], v[204:207], v[124:127], v[96:99]
    s_waitcnt lgkmcnt(0)
    v_mfma_f32_16x16x32_bf16 v[100:103], v[208:211], v[120:123], 0
    v_mfma_f32_16x16x32_bf16 v[100:103], v[212:215], v[124:127], v[100:103]
    v_add_u32 v5, s46, v5
    v_add_u32 v6, s46, v6
    v_add_u32 v8, s46, v8
    v_add_u32 v9, s46, v9
    v_add_u32 v10, s46, v10
    v_add_u32 v11, s46, v11
    s_nop 1
    v_and_b32 v104, v23, v88
    v_and_b32 v105, v23, v89
    v_and_b32 v106, v23, v90
    v_and_b32 v107, v23, v91
    v_and_b32 v108, v23, v92
    v_and_b32 v109, v23, v93
    v_and_b32 v110, v23, v94
    v_and_b32 v111, v23, v95
    v_and_b32 v112, v23, v96
    v_and_b32 v113, v23, v97
    v_and_b32 v114, v23, v98
    v_and_b32 v115, v23, v99
    v_and_b32 v116, v23, v100
    v_and_b32 v117, v23, v101
    v_and_b32 v118, v23, v102
    v_and_b32 v119, v23, v103
    v_sub_f32 v104, v88, v104
    v_sub_f32 v105, v89, v105
    v_sub_f32 v106, v90, v106
    v_sub_f32 v107, v91, v107
    v_sub_f32 v108, v92, v108
    v_sub_f32 v109, v93, v109
    v_sub_f32 v110, v94, v110
    v_sub_f32 v111, v95, v111
    v_sub_f32 v112, v96, v112
    v_sub_f32 v113, v97, v113
    v_sub_f32 v114, v98, v114
    v_sub_f32 v115, v99, v115
    v_sub_f32 v116, v100, v116
    v_sub_f32 v117, v101, v117
    v_sub_f32 v118, v102, v118
    v_sub_f32 v119, v103, v119
    v_perm_b32 v168, v105, v104, s43
    v_perm_b32 v169, v107, v106, s43
    v_perm_b32 v170, v109, v108, s43
    v_perm_b32 v171, v111, v110, s43
    v_perm_b32 v172, v113, v112, s43
    v_perm_b32 v173, v115, v114, s43
    v_perm_b32 v174, v117, v116, s43
    v_perm_b32 v175, v119, v118, s43
    s_barrier
    ds_read_b64_tr_b16 v[40:41], v5 offset:0
    ds_read_b64_tr_b16 v[42:43], v5 offset:4096
    ds_read_b64_tr_b16 v[44:45], v6 offset:0
    ds_read_b64_tr_b16 v[46:47], v6 offset:4096
    ds_read_b64_tr_b16 v[48:49], v5 offset:8192
    ds_read_b64_tr_b16 v[50:51], v5 offset:12288
    ds_read_b64_tr_b16 v[52:53], v6 offset:8192
    ds_read_b64_tr_b16 v[54:55], v6 offset:12288
    ds_read_b64_tr_b16 v[184:185], v8 offset:0
    ds_read_b64_tr_b16 v[186:187], v8 offset:2048
    ds_read_b64_tr_b16 v[188:189], v8 offset:4096
    ds_read_b64_tr_b16 v[190:191], v8 offset:6144
    s_waitcnt lgkmcnt(10)
    v_mfma_f32_16x16x32_bf16 v[128:131], v[40:43], v[168:171], v[128:131]
    s_waitcnt lgkmcnt(8)
    v_mfma_f32_16x16x32_bf16 v[132:135], v[44:47], v[168:171], v[132:135]
    s_waitcnt lgkmcnt(6)
    v_mfma_f32_16x16x32_bf16 v[128:131], v[48:51], v[172:175], v[128:131]
    s_waitcnt lgkmcnt(4)
    v_mfma_f32_16x16x32_bf16 v[132:135], v[52:55], v[172:175], v[132:135]
    ds_read_b64_tr_b16 v[192:193], v9 offset:0
    ds_read_b64_tr_b16 v[194:195], v9 offset:2048
    ds_read_b64_tr_b16 v[196:197], v9 offset:4096
    ds_read_b64_tr_b16 v[198:199], v9 offset:6144
    ds_read_b64_tr_b16 v[200:201], v10 offset:0
    ds_read_b64_tr_b16 v[202:203], v10 offset:2048
    ds_read_b64_tr_b16 v[204:205], v10 offset:4096
    ds_read_b64_tr_b16 v[206:207], v10 offset:6144
    s_waitcnt lgkmcnt(8)
    v_mfma_f32_16x16x32_bf16 v[88:91], v[184:187], v[120:123], 0
    v_mfma_f32_16x16x32_bf16 v[88:91], v[188:191], v[124:127], v[88:91]
    ds_read_b64_tr_b16 v[208:209], v11 offset:0
    ds_read_b64_tr_b16 v[210:211], v11 offset:2048
    ds_read_b64_tr_b16 v[212:213], v11 offset:4096
    ds_read_b64_tr_b16 v[214:215], v11 offset:6144
    s_waitcnt lgkmcnt(8)
    v_mfma_f32_16x16x32_bf16 v[92:95], v[192:195], v[120:123], 0
    v_mfma_f32_16x16x32_bf16 v[92:95], v[196:199], v[124:127], v[92:95]
    s_waitcnt lgkmcnt(4)
    v_mfma_f32_16x16x32_bf16 v[96:99], v[200:203], v[120:123], 0
    v_mfma_f32_16x16x32_bf16 v[96:99], v[204:207], v[124:127], v[96:99]
    s_waitcnt lgkmcnt(0)
    v_mfma_f32_16x16x32_bf16 v[100:103], v[208:211], v[120:123], 0
    v_mfma_f32_16x16x32_bf16 v[100:103], v[212:215], v[124:127], v[100:103]
    v_add_u32 v5, s46, v5
    v_add_u32 v6, s46, v6
    v_add_u32 v8, s46, v8
    v_add_u32 v9, s46, v9
    v_add_u32 v10, s46, v10
    v_add_u32 v11, s46, v11
    s_nop 1
    v_and_b32 v104, v23, v88
    v_and_b32 v105, v23, v89
    v_and_b32 v106, v23, v90
    v_and_b32 v107, v23, v91
    v_and_b32 v108, v23, v92
    v_and_b32 v109, v23, v93
    v_and_b32 v110, v23, v94
    v_and_b32 v111, v23, v95
    v_and_b32 v112, v23, v96
    v_and_b32 v113, v23, v97
    v_and_b32 v114, v23, v98
    v_and_b32 v115, v23, v99
    v_and_b32 v116, v23, v100
    v_and_b32 v117, v23, v101
    v_and_b32 v118, v23, v102
    v_and_b32 v119, v23, v103
    v_sub_f32 v104, v88, v104
    v_sub_f32 v105, v89, v105
    v_sub_f32 v106, v90, v106
    v_sub_f32 v107, v91, v107
    v_sub_f32 v108, v92, v108
    v_sub_f32 v109, v93, v109
    v_sub_f32 v110, v94, v110
    v_sub_f32 v111, v95, v111
    v_sub_f32 v112, v96, v112
    v_sub_f32 v113, v97, v113
    v_sub_f32 v114, v98, v114
    v_sub_f32 v115, v99, v115
    v_sub_f32 v116, v100, v116
    v_sub_f32 v117, v101, v117
    v_sub_f32 v118, v102, v118
    v_sub_f32 v119, v103, v119
    v_perm_b32 v176, v105, v104, s43
    v_perm_b32 v177, v107, v106, s43
    v_perm_b32 v178, v109, v108, s43
    v_perm_b32 v179, v111, v110, s43
    v_perm_b32 v180, v113, v112, s43
    v_perm_b32 v181, v115, v114, s43
    v_perm_b32 v182, v117, v116, s43
    v_perm_b32 v183, v119, v118, s43
    s_barrier
    ds_read_b64_tr_b16 v[40:41], v5 offset:0
    ds_read_b64_tr_b16 v[42:43], v5 offset:4096
    ds_read_b64_tr_b16 v[44:45], v6 offset:0
    ds_read_b64_tr_b16 v[46:47], v6 offset:4096
    ds_read_b64_tr_b16 v[48:49], v5 offset:8192
    ds_read_b64_tr_b16 v[50:51], v5 offset:12288
    ds_read_b64_tr_b16 v[52:53], v6 offset:8192
    ds_read_b64_tr_b16 v[54:55], v6 offset:12288
    ds_read_b64_tr_b16 v[184:185], v8 offset:0
    ds_read_b64_tr_b16 v[186:187], v8 offset:2048
    ds_read_b64_tr_b16 v[188:189], v8 offset:4096
    ds_read_b64_tr_b16 v[190:191], v8 offset:6144
    s_waitcnt lgkmcnt(10)
    v_mfma_f32_16x16x32_bf16 v[128:131], v[40:43], v[176:179], v[128:131]
    s_waitcnt lgkmcnt(8)
    v_mfma_f32_16x16x32_bf16 v[132:135], v[44:47], v[176:179], v[132:135]
    s_waitcnt lgkmcnt(6)
    v_mfma_f32_16x16x32_bf16 v[128:131], v[48:51], v[180:183], v[128:131]
    s_waitcnt lgkmcnt(4)
    v_mfma_f32_16x16x32_bf16 v[132:135], v[52:55], v[180:183], v[132:135]
    ds_read_b64_tr_b16 v[192:193], v9 offset:0
    ds_read_b64_tr_b16 v[194:195], v9 offset:2048
    ds_read_b64_tr_b16 v[196:197], v9 offset:4096
    ds_read_b64_tr_b16 v[198:199], v9 offset:6144
    ds_read_b64_tr_b16 v[200:201], v10 offset:0
    ds_read_b64_tr_b16 v[202:203], v10 offset:2048
    ds_read_b64_tr_b16 v[204:205], v10 offset:4096
    ds_read_b64_tr_b16 v[206:207], v10 offset:6144
    s_waitcnt lgkmcnt(8)
    v_mfma_f32_16x16x32_bf16 v[88:91], v[184:187], v[120:123], 0
    v_mfma_f32_16x16x32_bf16 v[88:91], v[188:191], v[124:127], v[88:91]
    ds_read_b64_tr_b16 v[208:209], v11 offset:0
    ds_read_b64_tr_b16 v[210:211], v11 offset:2048
    ds_read_b64_tr_b16 v[212:213], v11 offset:4096
    ds_read_b64_tr_b16 v[214:215], v11 offset:6144
    s_waitcnt lgkmcnt(8)
    v_mfma_f32_16x16x32_bf16 v[92:95], v[192:195], v[120:123], 0
    v_mfma_f32_16x16x32_bf16 v[92:95], v[196:199], v[124:127], v[92:95]
    s_waitcnt lgkmcnt(4)
    v_mfma_f32_16x16x32_bf16 v[96:99], v[200:203], v[120:123], 0
    v_mfma_f32_16x16x32_bf16 v[96:99], v[204:207], v[124:127], v[96:99]
    s_waitcnt lgkmcnt(0)
    v_mfma_f32_16x16x32_bf16 v[100:103], v[208:211], v[120:123], 0
    v_mfma_f32_16x16x32_bf16 v[100:103], v[212:215], v[124:127], v[100:103]
    v_add_u32 v5, s46, v5
    v_add_u32 v6, s46, v6
    v_add_u32 v8, s46, v8
    v_add_u32 v9, s46, v9
    v_add_u32 v10, s46, v10
    v_add_u32 v11, s46, v11
    s_nop 1
    v_and_b32 v104, v23, v88
    v_and_b32 v105, v23, v89
    v_and_b32 v106, v23, v90
    v_and_b32 v107, v23, v91
    v_and_b32 v108, v23, v92
    v_and_b32 v109, v23, v93
    v_and_b32 v110, v23, v94
    v_and_b32 v111, v23, v95
    v_and_b32 v112, v23, v96
    v_and_b32 v113, v23, v97
    v_and_b32 v114, v23, v98
    v_and_b32 v115, v23, v99
    v_and_b32 v116, v23, v100
    v_and_b32 v117, v23, v101
    v_and_b32 v118, v23, v102
    v_and_b32 v119, v23, v103
    v_sub_f32 v104, v88, v104
    v_sub_f32 v105, v89, v105
    v_sub_f32 v106, v90, v106
    v_sub_f32 v107, v91, v107
    v_sub_f32 v108, v92, v108
    v_sub_f32 v109, v93, v109
    v_sub_f32 v110, v94, v110
    v_sub_f32 v111, v95, v111
    v_sub_f32 v112, v96, v112
    v_sub_f32 v113, v97, v113
    v_sub_f32 v114, v98, v114
    v_sub_f32 v115, v99, v115
    v_sub_f32 v116, v100, v116
    v_sub_f32 v117, v101, v117
    v_sub_f32 v118, v102, v118
    v_sub_f32 v119, v103, v119
    v_perm_b32 v168, v105, v104, s43
    v_perm_b32 v169, v107, v106, s43
    v_perm_b32 v170, v109, v108, s43
    v_perm_b32 v171, v111, v110, s43
    v_perm_b32 v172, v113, v112, s43
    v_perm_b32 v173, v115, v114, s43
    v_perm_b32 v174, v117, v116, s43
    v_perm_b32 v175, v119, v118, s43
    s_barrier
    ds_read_b64_tr_b16 v[40:41], v5 offset:0
    ds_read_b64_tr_b16 v[42:43], v5 offset:4096
    ds_read_b64_tr_b16 v[44:45], v6 offset:0
    ds_read_b64_tr_b16 v[46:47], v6 offset:4096
    ds_read_b64_tr_b16 v[48:49], v5 offset:8192
    ds_read_b64_tr_b16 v[50:51], v5 offset:12288
    ds_read_b64_tr_b16 v[52:53], v6 offset:8192
    ds_read_b64_tr_b16 v[54:55], v6 offset:12288
    ds_read_b64_tr_b16 v[184:185], v8 offset:0
    ds_read_b64_tr_b16 v[186:187], v8 offset:2048
    ds_read_b64_tr_b16 v[188:189], v8 offset:4096
    ds_read_b64_tr_b16 v[190:191], v8 offset:6144
    s_waitcnt lgkmcnt(10)
    v_mfma_f32_16x16x32_bf16 v[128:131], v[40:43], v[168:171], v[128:131]
    s_waitcnt lgkmcnt(8)
    v_mfma_f32_16x16x32_bf16 v[132:135], v[44:47], v[168:171], v[132:135]
    s_waitcnt lgkmcnt(6)
    v_mfma_f32_16x16x32_bf16 v[128:131], v[48:51], v[172:175], v[128:131]
    s_waitcnt lgkmcnt(4)
    v_mfma_f32_16x16x32_bf16 v[132:135], v[52:55], v[172:175], v[132:135]
    ds_read_b64_tr_b16 v[192:193], v9 offset:0
    ds_read_b64_tr_b16 v[194:195], v9 offset:2048
    ds_read_b64_tr_b16 v[196:197], v9 offset:4096
    ds_read_b64_tr_b16 v[198:199], v9 offset:6144
    ds_read_b64_tr_b16 v[200:201], v10 offset:0
    ds_read_b64_tr_b16 v[202:203], v10 offset:2048
    ds_read_b64_tr_b16 v[204:205], v10 offset:4096
    ds_read_b64_tr_b16 v[206:207], v10 offset:6144
    s_waitcnt lgkmcnt(8)
    v_mfma_f32_16x16x32_bf16 v[88:91], v[184:187], v[120:123], 0
    v_mfma_f32_16x16x32_bf16 v[88:91], v[188:191], v[124:127], v[88:91]
    ds_read_b64_tr_b16 v[208:209], v11 offset:0
    ds_read_b64_tr_b16 v[210:211], v11 offset:2048
    ds_read_b64_tr_b16 v[212:213], v11 offset:4096
    ds_read_b64_tr_b16 v[214:215], v11 offset:6144
    s_waitcnt lgkmcnt(8)
    v_mfma_f32_16x16x32_bf16 v[92:95], v[192:195], v[120:123], 0
    v_mfma_f32_16x16x32_bf16 v[92:95], v[196:199], v[124:127], v[92:95]
    s_waitcnt lgkmcnt(4)
    v_mfma_f32_16x16x32_bf16 v[96:99], v[200:203], v[120:123], 0
    v_mfma_f32_16x16x32_bf16 v[96:99], v[204:207], v[124:127], v[96:99]
    s_waitcnt lgkmcnt(0)
    v_mfma_f32_16x16x32_bf16 v[100:103], v[208:211], v[120:123], 0
    v_mfma_f32_16x16x32_bf16 v[100:103], v[212:215], v[124:127], v[100:103]
    v_add_u32 v5, s46, v5
    v_add_u32 v6, s46, v6
    v_add_u32 v8, s46, v8
    v_add_u32 v9, s46, v9
    v_add_u32 v10, s46, v10
    v_add_u32 v11, s46, v11
    s_nop 1
    v_and_b32 v104, v23, v88
    v_and_b32 v105, v23, v89
    v_and_b32 v106, v23, v90
    v_and_b32 v107, v23, v91
    v_and_b32 v108, v23, v92
    v_and_b32 v109, v23, v93
    v_and_b32 v110, v23, v94
    v_and_b32 v111, v23, v95
    v_and_b32 v112, v23, v96
    v_and_b32 v113, v23, v97
    v_and_b32 v114, v23, v98
    v_and_b32 v115, v23, v99
    v_and_b32 v116, v23, v100
    v_and_b32 v117, v23, v101
    v_and_b32 v118, v23, v102
    v_and_b32 v119, v23, v103
    v_sub_f32 v104, v88, v104
    v_sub_f32 v105, v89, v105
    v_sub_f32 v106, v90, v106
    v_sub_f32 v107, v91, v107
    v_sub_f32 v108, v92, v108
    v_sub_f32 v109, v93, v109
    v_sub_f32 v110, v94, v110
    v_sub_f32 v111, v95, v111
    v_sub_f32 v112, v96, v112
    v_sub_f32 v113, v97, v113
    v_sub_f32 v114, v98, v114
    v_sub_f32 v115, v99, v115
    v_sub_f32 v116, v100, v116
    v_sub_f32 v117, v101, v117
    v_sub_f32 v118, v102, v118
    v_sub_f32 v119, v103, v119
    v_perm_b32 v176, v105, v104, s43
    v_perm_b32 v177, v107, v106, s43
    v_perm_b32 v178, v109, v108, s43
    v_perm_b32 v179, v111, v110, s43
    v_perm_b32 v180, v113, v112, s43
    v_perm_b32 v181, v115, v114, s43
    v_perm_b32 v182, v117, v116, s43
    v_perm_b32 v183, v119, v118, s43
    s_barrier
    ds_read_b64_tr_b16 v[40:41], v5 offset:0
    ds_read_b64_tr_b16 v[42:43], v5 offset:4096
    ds_read_b64_tr_b16 v[44:45], v6 offset:0
    ds_read_b64_tr_b16 v[46:47], v6 offset:4096
    ds_read_b64_tr_b16 v[48:49], v5 offset:8192
    ds_read_b64_tr_b16 v[50:51], v5 offset:12288
    ds_read_b64_tr_b16 v[52:53], v6 offset:8192
    ds_read_b64_tr_b16 v[54:55], v6 offset:12288
    ds_read_b64_tr_b16 v[184:185], v8 offset:0
    ds_read_b64_tr_b16 v[186:187], v8 offset:2048
    ds_read_b64_tr_b16 v[188:189], v8 offset:4096
    ds_read_b64_tr_b16 v[190:191], v8 offset:6144
    s_waitcnt lgkmcnt(10)
    v_mfma_f32_16x16x32_bf16 v[128:131], v[40:43], v[176:179], v[128:131]
    s_waitcnt lgkmcnt(8)
    v_mfma_f32_16x16x32_bf16 v[132:135], v[44:47], v[176:179], v[132:135]
    s_waitcnt lgkmcnt(6)
    v_mfma_f32_16x16x32_bf16 v[128:131], v[48:51], v[180:183], v[128:131]
    s_waitcnt lgkmcnt(4)
    v_mfma_f32_16x16x32_bf16 v[132:135], v[52:55], v[180:183], v[132:135]
    ds_read_b64_tr_b16 v[192:193], v9 offset:0
    ds_read_b64_tr_b16 v[194:195], v9 offset:2048
    ds_read_b64_tr_b16 v[196:197], v9 offset:4096
    ds_read_b64_tr_b16 v[198:199], v9 offset:6144
    ds_read_b64_tr_b16 v[200:201], v10 offset:0
    ds_read_b64_tr_b16 v[202:203], v10 offset:2048
    ds_read_b64_tr_b16 v[204:205], v10 offset:4096
    ds_read_b64_tr_b16 v[206:207], v10 offset:6144
    s_waitcnt lgkmcnt(8)
    v_mfma_f32_16x16x32_bf16 v[88:91], v[184:187], v[120:123], 0
    v_mfma_f32_16x16x32_bf16 v[88:91], v[188:191], v[124:127], v[88:91]
    ds_read_b64_tr_b16 v[208:209], v11 offset:0
    ds_read_b64_tr_b16 v[210:211], v11 offset:2048
    ds_read_b64_tr_b16 v[212:213], v11 offset:4096
    ds_read_b64_tr_b16 v[214:215], v11 offset:6144
    s_waitcnt lgkmcnt(8)
    v_mfma_f32_16x16x32_bf16 v[92:95], v[192:195], v[120:123], 0
    v_mfma_f32_16x16x32_bf16 v[92:95], v[196:199], v[124:127], v[92:95]
    s_waitcnt lgkmcnt(4)
    v_mfma_f32_16x16x32_bf16 v[96:99], v[200:203], v[120:123], 0
    v_mfma_f32_16x16x32_bf16 v[96:99], v[204:207], v[124:127], v[96:99]
    s_waitcnt lgkmcnt(0)
    v_mfma_f32_16x16x32_bf16 v[100:103], v[208:211], v[120:123], 0
    v_mfma_f32_16x16x32_bf16 v[100:103], v[212:215], v[124:127], v[100:103]
    v_add_u32 v5, s47, v5
    v_add_u32 v6, s47, v6
    v_add_u32 v8, s47, v8
    v_add_u32 v9, s47, v9
    v_add_u32 v10, s47, v10
    v_add_u32 v11, s47, v11
    s_nop 1
    v_and_b32 v104, v23, v88
    v_and_b32 v105, v23, v89
    v_and_b32 v106, v23, v90
    v_and_b32 v107, v23, v91
    v_and_b32 v108, v23, v92
    v_and_b32 v109, v23, v93
    v_and_b32 v110, v23, v94
    v_and_b32 v111, v23, v95
    v_and_b32 v112, v23, v96
    v_and_b32 v113, v23, v97
    v_and_b32 v114, v23, v98
    v_and_b32 v115, v23, v99
    v_and_b32 v116, v23, v100
    v_and_b32 v117, v23, v101
    v_and_b32 v118, v23, v102
    v_and_b32 v119, v23, v103
    v_sub_f32 v104, v88, v104
    v_sub_f32 v105, v89, v105
    v_sub_f32 v106, v90, v106
    v_sub_f32 v107, v91, v107
    v_sub_f32 v108, v92, v108
    v_sub_f32 v109, v93, v109
    v_sub_f32 v110, v94, v110
    v_sub_f32 v111, v95, v111
    v_sub_f32 v112, v96, v112
    v_sub_f32 v113, v97, v113
    v_sub_f32 v114, v98, v114
    v_sub_f32 v115, v99, v115
    v_sub_f32 v116, v100, v116
    v_sub_f32 v117, v101, v117
    v_sub_f32 v118, v102, v118
    v_sub_f32 v119, v103, v119
    v_perm_b32 v168, v105, v104, s43
    v_perm_b32 v169, v107, v106, s43
    v_perm_b32 v170, v109, v108, s43
    v_perm_b32 v171, v111, v110, s43
    v_perm_b32 v172, v113, v112, s43
    v_perm_b32 v173, v115, v114, s43
    v_perm_b32 v174, v117, v116, s43
    v_perm_b32 v175, v119, v118, s43
    s_barrier
    ds_read_b64_tr_b16 v[40:41], v5 offset:0
    ds_read_b64_tr_b16 v[42:43], v5 offset:4096
    ds_read_b64_tr_b16 v[44:45], v6 offset:0
    ds_read_b64_tr_b16 v[46:47], v6 offset:4096
    ds_read_b64_tr_b16 v[48:49], v5 offset:8192
    ds_read_b64_tr_b16 v[50:51], v5 offset:12288
    ds_read_b64_tr_b16 v[52:53], v6 offset:8192
    ds_read_b64_tr_b16 v[54:55], v6 offset:12288
    ds_read_b64_tr_b16 v[184:185], v8 offset:0
    ds_read_b64_tr_b16 v[186:187], v8 offset:2048
    ds_read_b64_tr_b16 v[188:189], v8 offset:4096
    ds_read_b64_tr_b16 v[190:191], v8 offset:6144
    s_waitcnt lgkmcnt(10)
    v_mfma_f32_16x16x32_bf16 v[128:131], v[40:43], v[168:171], v[128:131]
    s_waitcnt lgkmcnt(8)
    v_mfma_f32_16x16x32_bf16 v[132:135], v[44:47], v[168:171], v[132:135]
    s_waitcnt lgkmcnt(6)
    v_mfma_f32_16x16x32_bf16 v[128:131], v[48:51], v[172:175], v[128:131]
    s_waitcnt lgkmcnt(4)
    v_mfma_f32_16x16x32_bf16 v[132:135], v[52:55], v[172:175], v[132:135]
    ds_read_b64_tr_b16 v[192:193], v9 offset:0
    ds_read_b64_tr_b16 v[194:195], v9 offset:2048
    ds_read_b64_tr_b16 v[196:197], v9 offset:4096
    ds_read_b64_tr_b16 v[198:199], v9 offset:6144
    ds_read_b64_tr_b16 v[200:201], v10 offset:0
    ds_read_b64_tr_b16 v[202:203], v10 offset:2048
    ds_read_b64_tr_b16 v[204:205], v10 offset:4096
    ds_read_b64_tr_b16 v[206:207], v10 offset:6144
    s_waitcnt lgkmcnt(8)
    v_mfma_f32_16x16x32_bf16 v[88:91], v[184:187], v[120:123], 0
    v_mfma_f32_16x16x32_bf16 v[88:91], v[188:191], v[124:127], v[88:91]
    ds_read_b64_tr_b16 v[208:209], v11 offset:0
    ds_read_b64_tr_b16 v[210:211], v11 offset:2048
    ds_read_b64_tr_b16 v[212:213], v11 offset:4096
    ds_read_b64_tr_b16 v[214:215], v11 offset:6144
    s_waitcnt lgkmcnt(8)
    v_mfma_f32_16x16x32_bf16 v[92:95], v[192:195], v[120:123], 0
    v_mfma_f32_16x16x32_bf16 v[92:95], v[196:199], v[124:127], v[92:95]
    s_waitcnt lgkmcnt(4)
    v_mfma_f32_16x16x32_bf16 v[96:99], v[200:203], v[120:123], 0
    v_mfma_f32_16x16x32_bf16 v[96:99], v[204:207], v[124:127], v[96:99]
    s_waitcnt lgkmcnt(0)
    v_mfma_f32_16x16x32_bf16 v[100:103], v[208:211], v[120:123], 0
    v_mfma_f32_16x16x32_bf16 v[100:103], v[212:215], v[124:127], v[100:103]
    v_add_u32 v5, s46, v5
    v_add_u32 v6, s46, v6
    v_add_u32 v8, s46, v8
    v_add_u32 v9, s46, v9
    v_add_u32 v10, s46, v10
    v_add_u32 v11, s46, v11
    s_nop 1
    v_and_b32 v104, v23, v88
    v_and_b32 v105, v23, v89
    v_and_b32 v106, v23, v90
    v_and_b32 v107, v23, v91
    v_and_b32 v108, v23, v92
    v_and_b32 v109, v23, v93
    v_and_b32 v110, v23, v94
    v_and_b32 v111, v23, v95
    v_and_b32 v112, v23, v96
    v_and_b32 v113, v23, v97
    v_and_b32 v114, v23, v98
    v_and_b32 v115, v23, v99
    v_and_b32 v116, v23, v100
    v_and_b32 v117, v23, v101
    v_and_b32 v118, v23, v102
    v_and_b32 v119, v23, v103
    v_sub_f32 v104, v88, v104
    v_sub_f32 v105, v89, v105
    v_sub_f32 v106, v90, v106
    v_sub_f32 v107, v91, v107
    v_sub_f32 v108, v92, v108
    v_sub_f32 v109, v93, v109
    v_sub_f32 v110, v94, v110
    v_sub_f32 v111, v95, v111
    v_sub_f32 v112, v96, v112
    v_sub_f32 v113, v97, v113
    v_sub_f32 v114, v98, v114
    v_sub_f32 v115, v99, v115
    v_sub_f32 v116, v100, v116
    v_sub_f32 v117, v101, v117
    v_sub_f32 v118, v102, v118
    v_sub_f32 v119, v103, v119
    v_perm_b32 v176, v105, v104, s43
    v_perm_b32 v177, v107, v106, s43
    v_perm_b32 v178, v109, v108, s43
    v_perm_b32 v179, v111, v110, s43
    v_perm_b32 v180, v113, v112, s43
    v_perm_b32 v181, v115, v114, s43
    v_perm_b32 v182, v117, v116, s43
    v_perm_b32 v183, v119, v118, s43
    s_barrier
    ds_read_b64_tr_b16 v[40:41], v5 offset:0
    ds_read_b64_tr_b16 v[42:43], v5 offset:4096
    ds_read_b64_tr_b16 v[44:45], v6 offset:0
    ds_read_b64_tr_b16 v[46:47], v6 offset:4096
    ds_read_b64_tr_b16 v[48:49], v5 offset:8192
    ds_read_b64_tr_b16 v[50:51], v5 offset:12288
    ds_read_b64_tr_b16 v[52:53], v6 offset:8192
    ds_read_b64_tr_b16 v[54:55], v6 offset:12288
    ds_read_b64_tr_b16 v[184:185], v8 offset:0
    ds_read_b64_tr_b16 v[186:187], v8 offset:2048
    ds_read_b64_tr_b16 v[188:189], v8 offset:4096
    ds_read_b64_tr_b16 v[190:191], v8 offset:6144
    s_waitcnt lgkmcnt(10)
    v_mfma_f32_16x16x32_bf16 v[128:131], v[40:43], v[176:179], v[128:131]
    s_waitcnt lgkmcnt(8)
    v_mfma_f32_16x16x32_bf16 v[132:135], v[44:47], v[176:179], v[132:135]
    s_waitcnt lgkmcnt(6)
    v_mfma_f32_16x16x32_bf16 v[128:131], v[48:51], v[180:183], v[128:131]
    s_waitcnt lgkmcnt(4)
    v_mfma_f32_16x16x32_bf16 v[132:135], v[52:55], v[180:183], v[132:135]
    ds_read_b64_tr_b16 v[192:193], v9 offset:0
    ds_read_b64_tr_b16 v[194:195], v9 offset:2048
    ds_read_b64_tr_b16 v[196:197], v9 offset:4096
    ds_read_b64_tr_b16 v[198:199], v9 offset:6144
    ds_read_b64_tr_b16 v[200:201], v10 offset:0
    ds_read_b64_tr_b16 v[202:203], v10 offset:2048
    ds_read_b64_tr_b16 v[204:205], v10 offset:4096
    ds_read_b64_tr_b16 v[206:207], v10 offset:6144
    s_waitcnt lgkmcnt(8)
    v_mfma_f32_16x16x32_bf16 v[88:91], v[184:187], v[120:123], 0
    v_mfma_f32_16x16x32_bf16 v[88:91], v[188:191], v[124:127], v[88:91]
    ds_read_b64_tr_b16 v[208:209], v11 offset:0
    ds_read_b64_tr_b16 v[210:211], v11 offset:2048
    ds_read_b64_tr_b16 v[212:213], v11 offset:4096
    ds_read_b64_tr_b16 v[214:215], v11 offset:6144
    s_waitcnt lgkmcnt(8)
    v_mfma_f32_16x16x32_bf16 v[92:95], v[192:195], v[120:123], 0
    v_mfma_f32_16x16x32_bf16 v[92:95], v[196:199], v[124:127], v[92:95]
    s_waitcnt lgkmcnt(4)
    v_mfma_f32_16x16x32_bf16 v[96:99], v[200:203], v[120:123], 0
    v_mfma_f32_16x16x32_bf16 v[96:99], v[204:207], v[124:127], v[96:99]
    s_waitcnt lgkmcnt(0)
    v_mfma_f32_16x16x32_bf16 v[100:103], v[208:211], v[120:123], 0
    v_mfma_f32_16x16x32_bf16 v[100:103], v[212:215], v[124:127], v[100:103]
    v_add_u32 v5, s46, v5
    v_add_u32 v6, s46, v6
    v_add_u32 v8, s46, v8
    v_add_u32 v9, s46, v9
    v_add_u32 v10, s46, v10
    v_add_u32 v11, s46, v11
    s_nop 1
    v_and_b32 v104, v23, v88
    v_and_b32 v105, v23, v89
    v_and_b32 v106, v23, v90
    v_and_b32 v107, v23, v91
    v_and_b32 v108, v23, v92
    v_and_b32 v109, v23, v93
    v_and_b32 v110, v23, v94
    v_and_b32 v111, v23, v95
    v_and_b32 v112, v23, v96
    v_and_b32 v113, v23, v97
    v_and_b32 v114, v23, v98
    v_and_b32 v115, v23, v99
    v_and_b32 v116, v23, v100
    v_and_b32 v117, v23, v101
    v_and_b32 v118, v23, v102
    v_and_b32 v119, v23, v103
    v_sub_f32 v104, v88, v104
    v_sub_f32 v105, v89, v105
    v_sub_f32 v106, v90, v106
    v_sub_f32 v107, v91, v107
    v_sub_f32 v108, v92, v108
    v_sub_f32 v109, v93, v109
    v_sub_f32 v110, v94, v110
    v_sub_f32 v111, v95, v111
    v_sub_f32 v112, v96, v112
    v_sub_f32 v113, v97, v113
    v_sub_f32 v114, v98, v114
    v_sub_f32 v115, v99, v115
    v_sub_f32 v116, v100, v116
    v_sub_f32 v117, v101, v117
    v_sub_f32 v118, v102, v118
    v_sub_f32 v119, v103, v119
    v_perm_b32 v168, v105, v104, s43
    v_perm_b32 v169, v107, v106, s43
    v_perm_b32 v170, v109, v108, s43
    v_perm_b32 v171, v111, v110, s43
    v_perm_b32 v172, v113, v112, s43
    v_perm_b32 v173, v115, v114, s43
    v_perm_b32 v174, v117, v116, s43
    v_perm_b32 v175, v119, v118, s43
    s_barrier
    ds_read_b64_tr_b16 v[40:41], v5 offset:0
    ds_read_b64_tr_b16 v[42:43], v5 offset:4096
    ds_read_b64_tr_b16 v[44:45], v6 offset:0
    ds_read_b64_tr_b16 v[46:47], v6 offset:4096
    ds_read_b64_tr_b16 v[48:49], v5 offset:8192
    ds_read_b64_tr_b16 v[50:51], v5 offset:12288
    ds_read_b64_tr_b16 v[52:53], v6 offset:8192
    ds_read_b64_tr_b16 v[54:55], v6 offset:12288
    ds_read_b64_tr_b16 v[184:185], v8 offset:0
    ds_read_b64_tr_b16 v[186:187], v8 offset:2048
    ds_read_b64_tr_b16 v[188:189], v8 offset:4096
    ds_read_b64_tr_b16 v[190:191], v8 offset:6144
    s_waitcnt lgkmcnt(10)
    v_mfma_f32_16x16x32_bf16 v[128:131], v[40:43], v[168:171], v[128:131]
    s_waitcnt lgkmcnt(8)
    v_mfma_f32_16x16x32_bf16 v[132:135], v[44:47], v[168:171], v[132:135]
    s_waitcnt lgkmcnt(6)
    v_mfma_f32_16x16x32_bf16 v[128:131], v[48:51], v[172:175], v[128:131]
    s_waitcnt lgkmcnt(4)
    v_mfma_f32_16x16x32_bf16 v[132:135], v[52:55], v[172:175], v[132:135]
    ds_read_b64_tr_b16 v[192:193], v9 offset:0
    ds_read_b64_tr_b16 v[194:195], v9 offset:2048
    ds_read_b64_tr_b16 v[196:197], v9 offset:4096
    ds_read_b64_tr_b16 v[198:199], v9 offset:6144
    ds_read_b64_tr_b16 v[200:201], v10 offset:0
    ds_read_b64_tr_b16 v[202:203], v10 offset:2048
    ds_read_b64_tr_b16 v[204:205], v10 offset:4096
    ds_read_b64_tr_b16 v[206:207], v10 offset:6144
    s_waitcnt lgkmcnt(8)
    v_mfma_f32_16x16x32_bf16 v[88:91], v[184:187], v[120:123], 0
    v_mfma_f32_16x16x32_bf16 v[88:91], v[188:191], v[124:127], v[88:91]
    ds_read_b64_tr_b16 v[208:209], v11 offset:0
    ds_read_b64_tr_b16 v[210:211], v11 offset:2048
    ds_read_b64_tr_b16 v[212:213], v11 offset:4096
    ds_read_b64_tr_b16 v[214:215], v11 offset:6144
    s_waitcnt lgkmcnt(8)
    v_mfma_f32_16x16x32_bf16 v[92:95], v[192:195], v[120:123], 0
    v_mfma_f32_16x16x32_bf16 v[92:95], v[196:199], v[124:127], v[92:95]
    s_waitcnt lgkmcnt(4)
    v_mfma_f32_16x16x32_bf16 v[96:99], v[200:203], v[120:123], 0
    v_mfma_f32_16x16x32_bf16 v[96:99], v[204:207], v[124:127], v[96:99]
    s_waitcnt lgkmcnt(0)
    v_mfma_f32_16x16x32_bf16 v[100:103], v[208:211], v[120:123], 0
    v_mfma_f32_16x16x32_bf16 v[100:103], v[212:215], v[124:127], v[100:103]
    v_add_u32 v5, s46, v5
    v_add_u32 v6, s46, v6
    v_add_u32 v8, s46, v8
    v_add_u32 v9, s46, v9
    v_add_u32 v10, s46, v10
    v_add_u32 v11, s46, v11
    s_nop 1
    v_and_b32 v104, v23, v88
    v_and_b32 v105, v23, v89
    v_and_b32 v106, v23, v90
    v_and_b32 v107, v23, v91
    v_and_b32 v108, v23, v92
    v_and_b32 v109, v23, v93
    v_and_b32 v110, v23, v94
    v_and_b32 v111, v23, v95
    v_and_b32 v112, v23, v96
    v_and_b32 v113, v23, v97
    v_and_b32 v114, v23, v98
    v_and_b32 v115, v23, v99
    v_and_b32 v116, v23, v100
    v_and_b32 v117, v23, v101
    v_and_b32 v118, v23, v102
    v_and_b32 v119, v23, v103
    v_sub_f32 v104, v88, v104
    v_sub_f32 v105, v89, v105
    v_sub_f32 v106, v90, v106
    v_sub_f32 v107, v91, v107
    v_sub_f32 v108, v92, v108
    v_sub_f32 v109, v93, v109
    v_sub_f32 v110, v94, v110
    v_sub_f32 v111, v95, v111
    v_sub_f32 v112, v96, v112
    v_sub_f32 v113, v97, v113
    v_sub_f32 v114, v98, v114
    v_sub_f32 v115, v99, v115
    v_sub_f32 v116, v100, v116
    v_sub_f32 v117, v101, v117
    v_sub_f32 v118, v102, v118
    v_sub_f32 v119, v103, v119
    v_perm_b32 v176, v105, v104, s43
    v_perm_b32 v177, v107, v106, s43
    v_perm_b32 v178, v109, v108, s43
    v_perm_b32 v179, v111, v110, s43
    v_perm_b32 v180, v113, v112, s43
    v_perm_b32 v181, v115, v114, s43
    v_perm_b32 v182, v117, v116, s43
    v_perm_b32 v183, v119, v118, s43
    s_barrier
    ds_read_b64_tr_b16 v[40:41], v5 offset:0
    ds_read_b64_tr_b16 v[42:43], v5 offset:4096
    ds_read_b64_tr_b16 v[44:45], v6 offset:0
    ds_read_b64_tr_b16 v[46:47], v6 offset:4096
    ds_read_b64_tr_b16 v[48:49], v5 offset:8192
    ds_read_b64_tr_b16 v[50:51], v5 offset:12288
    ds_read_b64_tr_b16 v[52:53], v6 offset:8192
    ds_read_b64_tr_b16 v[54:55], v6 offset:12288
    ds_read_b64_tr_b16 v[184:185], v8 offset:0
    ds_read_b64_tr_b16 v[186:187], v8 offset:2048
    ds_read_b64_tr_b16 v[188:189], v8 offset:4096
    ds_read_b64_tr_b16 v[190:191], v8 offset:6144
    s_waitcnt lgkmcnt(10)
    v_mfma_f32_16x16x32_bf16 v[128:131], v[40:43], v[176:179], v[128:131]
    s_waitcnt lgkmcnt(8)
    v_mfma_f32_16x16x32_bf16 v[132:135], v[44:47], v[176:179], v[132:135]
    s_waitcnt lgkmcnt(6)
    v_mfma_f32_16x16x32_bf16 v[128:131], v[48:51], v[180:183], v[128:131]
    s_waitcnt lgkmcnt(4)
    v_mfma_f32_16x16x32_bf16 v[132:135], v[52:55], v[180:183], v[132:135]
    ds_read_b64_tr_b16 v[192:193], v9 offset:0
    ds_read_b64_tr_b16 v[194:195], v9 offset:2048
    ds_read_b64_tr_b16 v[196:197], v9 offset:4096
    ds_read_b64_tr_b16 v[198:199], v9 offset:6144
    ds_read_b64_tr_b16 v[200:201], v10 offset:0
    ds_read_b64_tr_b16 v[202:203], v10 offset:2048
    ds_read_b64_tr_b16 v[204:205], v10 offset:4096
    ds_read_b64_tr_b16 v[206:207], v10 offset:6144
    s_waitcnt lgkmcnt(8)
    v_mfma_f32_16x16x32_bf16 v[88:91], v[184:187], v[120:123], 0
    v_mfma_f32_16x16x32_bf16 v[88:91], v[188:191], v[124:127], v[88:91]
    ds_read_b64_tr_b16 v[208:209], v11 offset:0
    ds_read_b64_tr_b16 v[210:211], v11 offset:2048
    ds_read_b64_tr_b16 v[212:213], v11 offset:4096
    ds_read_b64_tr_b16 v[214:215], v11 offset:6144
    s_waitcnt lgkmcnt(8)
    v_mfma_f32_16x16x32_bf16 v[92:95], v[192:195], v[120:123], 0
    v_mfma_f32_16x16x32_bf16 v[92:95], v[196:199], v[124:127], v[92:95]
    s_waitcnt lgkmcnt(4)
    v_mfma_f32_16x16x32_bf16 v[96:99], v[200:203], v[120:123], 0
    v_mfma_f32_16x16x32_bf16 v[96:99], v[204:207], v[124:127], v[96:99]
    s_waitcnt lgkmcnt(0)
    v_mfma_f32_16x16x32_bf16 v[100:103], v[208:211], v[120:123], 0
    v_mfma_f32_16x16x32_bf16 v[100:103], v[212:215], v[124:127], v[100:103]
    v_add_u32 v5, s46, v5
    v_add_u32 v6, s46, v6
    v_add_u32 v8, s46, v8
    v_add_u32 v9, s46, v9
    v_add_u32 v10, s46, v10
    v_add_u32 v11, s46, v11
    s_nop 1
    v_and_b32 v104, v23, v88
    v_and_b32 v105, v23, v89
    v_and_b32 v106, v23, v90
    v_and_b32 v107, v23, v91
    v_and_b32 v108, v23, v92
    v_and_b32 v109, v23, v93
    v_and_b32 v110, v23, v94
    v_and_b32 v111, v23, v95
    v_and_b32 v112, v23, v96
    v_and_b32 v113, v23, v97
    v_and_b32 v114, v23, v98
    v_and_b32 v115, v23, v99
    v_and_b32 v116, v23, v100
    v_and_b32 v117, v23, v101
    v_and_b32 v118, v23, v102
    v_and_b32 v119, v23, v103
    v_sub_f32 v104, v88, v104
    v_sub_f32 v105, v89, v105
    v_sub_f32 v106, v90, v106
    v_sub_f32 v107, v91, v107
    v_sub_f32 v108, v92, v108
    v_sub_f32 v109, v93, v109
    v_sub_f32 v110, v94, v110
    v_sub_f32 v111, v95, v111
    v_sub_f32 v112, v96, v112
    v_sub_f32 v113, v97, v113
    v_sub_f32 v114, v98, v114
    v_sub_f32 v115, v99, v115
    v_sub_f32 v116, v100, v116
    v_sub_f32 v117, v101, v117
    v_sub_f32 v118, v102, v118
    v_sub_f32 v119, v103, v119
    v_perm_b32 v168, v105, v104, s43
    v_perm_b32 v169, v107, v106, s43
    v_perm_b32 v170, v109, v108, s43
    v_perm_b32 v171, v111, v110, s43
    v_perm_b32 v172, v113, v112, s43
    v_perm_b32 v173, v115, v114, s43
    v_perm_b32 v174, v117, v116, s43
    v_perm_b32 v175, v119, v118, s43
    s_barrier
    ds_read_b64_tr_b16 v[40:41], v5 offset:0
    ds_read_b64_tr_b16 v[42:43], v5 offset:4096
    ds_read_b64_tr_b16 v[44:45], v6 offset:0
    ds_read_b64_tr_b16 v[46:47], v6 offset:4096
    ds_read_b64_tr_b16 v[48:49], v5 offset:8192
    ds_read_b64_tr_b16 v[50:51], v5 offset:12288
    ds_read_b64_tr_b16 v[52:53], v6 offset:8192
    ds_read_b64_tr_b16 v[54:55], v6 offset:12288
    ds_read_b64_tr_b16 v[184:185], v8 offset:0
    ds_read_b64_tr_b16 v[186:187], v8 offset:2048
    ds_read_b64_tr_b16 v[188:189], v8 offset:4096
    ds_read_b64_tr_b16 v[190:191], v8 offset:6144
    s_waitcnt lgkmcnt(10)
    v_mfma_f32_16x16x32_bf16 v[128:131], v[40:43], v[168:171], v[128:131]
    s_waitcnt lgkmcnt(8)
    v_mfma_f32_16x16x32_bf16 v[132:135], v[44:47], v[168:171], v[132:135]
    s_waitcnt lgkmcnt(6)
    v_mfma_f32_16x16x32_bf16 v[128:131], v[48:51], v[172:175], v[128:131]
    s_waitcnt lgkmcnt(4)
    v_mfma_f32_16x16x32_bf16 v[132:135], v[52:55], v[172:175], v[132:135]
    ds_read_b64_tr_b16 v[192:193], v9 offset:0
    ds_read_b64_tr_b16 v[194:195], v9 offset:2048
    ds_read_b64_tr_b16 v[196:197], v9 offset:4096
    ds_read_b64_tr_b16 v[198:199], v9 offset:6144
    ds_read_b64_tr_b16 v[200:201], v10 offset:0
    ds_read_b64_tr_b16 v[202:203], v10 offset:2048
    ds_read_b64_tr_b16 v[204:205], v10 offset:4096
    ds_read_b64_tr_b16 v[206:207], v10 offset:6144
    s_waitcnt lgkmcnt(8)
    v_mfma_f32_16x16x32_bf16 v[88:91], v[184:187], v[120:123], 0
    v_mfma_f32_16x16x32_bf16 v[88:91], v[188:191], v[124:127], v[88:91]
    ds_read_b64_tr_b16 v[208:209], v11 offset:0
    ds_read_b64_tr_b16 v[210:211], v11 offset:2048
    ds_read_b64_tr_b16 v[212:213], v11 offset:4096
    ds_read_b64_tr_b16 v[214:215], v11 offset:6144
    s_waitcnt lgkmcnt(8)
    v_mfma_f32_16x16x32_bf16 v[92:95], v[192:195], v[120:123], 0
    v_mfma_f32_16x16x32_bf16 v[92:95], v[196:199], v[124:127], v[92:95]
    s_waitcnt lgkmcnt(4)
    v_mfma_f32_16x16x32_bf16 v[96:99], v[200:203], v[120:123], 0
    v_mfma_f32_16x16x32_bf16 v[96:99], v[204:207], v[124:127], v[96:99]
    s_waitcnt lgkmcnt(0)
    v_mfma_f32_16x16x32_bf16 v[100:103], v[208:211], v[120:123], 0
    v_mfma_f32_16x16x32_bf16 v[100:103], v[212:215], v[124:127], v[100:103]
    v_add_u32 v5, s46, v5
    v_add_u32 v6, s46, v6
    v_add_u32 v8, s46, v8
    v_add_u32 v9, s46, v9
    v_add_u32 v10, s46, v10
    v_add_u32 v11, s46, v11
    s_nop 1
    v_and_b32 v104, v23, v88
    v_and_b32 v105, v23, v89
    v_and_b32 v106, v23, v90
    v_and_b32 v107, v23, v91
    v_and_b32 v108, v23, v92
    v_and_b32 v109, v23, v93
    v_and_b32 v110, v23, v94
    v_and_b32 v111, v23, v95
    v_and_b32 v112, v23, v96
    v_and_b32 v113, v23, v97
    v_and_b32 v114, v23, v98
    v_and_b32 v115, v23, v99
    v_and_b32 v116, v23, v100
    v_and_b32 v117, v23, v101
    v_and_b32 v118, v23, v102
    v_and_b32 v119, v23, v103
    v_sub_f32 v104, v88, v104
    v_sub_f32 v105, v89, v105
    v_sub_f32 v106, v90, v106
    v_sub_f32 v107, v91, v107
    v_sub_f32 v108, v92, v108
    v_sub_f32 v109, v93, v109
    v_sub_f32 v110, v94, v110
    v_sub_f32 v111, v95, v111
    v_sub_f32 v112, v96, v112
    v_sub_f32 v113, v97, v113
    v_sub_f32 v114, v98, v114
    v_sub_f32 v115, v99, v115
    v_sub_f32 v116, v100, v116
    v_sub_f32 v117, v101, v117
    v_sub_f32 v118, v102, v118
    v_sub_f32 v119, v103, v119
    v_perm_b32 v176, v105, v104, s43
    v_perm_b32 v177, v107, v106, s43
    v_perm_b32 v178, v109, v108, s43
    v_perm_b32 v179, v111, v110, s43
    v_perm_b32 v180, v113, v112, s43
    v_perm_b32 v181, v115, v114, s43
    v_perm_b32 v182, v117, v116, s43
    v_perm_b32 v183, v119, v118, s43
    s_barrier
    ds_read_b64_tr_b16 v[40:41], v5 offset:0
    ds_read_b64_tr_b16 v[42:43], v5 offset:4096
    ds_read_b64_tr_b16 v[44:45], v6 offset:0
    ds_read_b64_tr_b16 v[46:47], v6 offset:4096
    ds_read_b64_tr_b16 v[48:49], v5 offset:8192
    ds_read_b64_tr_b16 v[50:51], v5 offset:12288
    ds_read_b64_tr_b16 v[52:53], v6 offset:8192
    ds_read_b64_tr_b16 v[54:55], v6 offset:12288
    ds_read_b64_tr_b16 v[184:185], v8 offset:0
    ds_read_b64_tr_b16 v[186:187], v8 offset:2048
    ds_read_b64_tr_b16 v[188:189], v8 offset:4096
    ds_read_b64_tr_b16 v[190:191], v8 offset:6144
    s_waitcnt lgkmcnt(10)
    v_mfma_f32_16x16x32_bf16 v[128:131], v[40:43], v[176:179], v[128:131]
    s_waitcnt lgkmcnt(8)
    v_mfma_f32_16x16x32_bf16 v[132:135], v[44:47], v[176:179], v[132:135]
    s_waitcnt lgkmcnt(6)
    v_mfma_f32_16x16x32_bf16 v[128:131], v[48:51], v[180:183], v[128:131]
    s_waitcnt lgkmcnt(4)
    v_mfma_f32_16x16x32_bf16 v[132:135], v[52:55], v[180:183], v[132:135]
    ds_read_b64_tr_b16 v[192:193], v9 offset:0
    ds_read_b64_tr_b16 v[194:195], v9 offset:2048
    ds_read_b64_tr_b16 v[196:197], v9 offset:4096
    ds_read_b64_tr_b16 v[198:199], v9 offset:6144
    ds_read_b64_tr_b16 v[200:201], v10 offset:0
    ds_read_b64_tr_b16 v[202:203], v10 offset:2048
    ds_read_b64_tr_b16 v[204:205], v10 offset:4096
    ds_read_b64_tr_b16 v[206:207], v10 offset:6144
    s_waitcnt lgkmcnt(8)
    v_mfma_f32_16x16x32_bf16 v[88:91], v[184:187], v[120:123], 0
    v_mfma_f32_16x16x32_bf16 v[88:91], v[188:191], v[124:127], v[88:91]
    ds_read_b64_tr_b16 v[208:209], v11 offset:0
    ds_read_b64_tr_b16 v[210:211], v11 offset:2048
    ds_read_b64_tr_b16 v[212:213], v11 offset:4096
    ds_read_b64_tr_b16 v[214:215], v11 offset:6144
    s_waitcnt lgkmcnt(8)
    v_mfma_f32_16x16x32_bf16 v[92:95], v[192:195], v[120:123], 0
    v_mfma_f32_16x16x32_bf16 v[92:95], v[196:199], v[124:127], v[92:95]
    s_waitcnt lgkmcnt(4)
    v_mfma_f32_16x16x32_bf16 v[96:99], v[200:203], v[120:123], 0
    v_mfma_f32_16x16x32_bf16 v[96:99], v[204:207], v[124:127], v[96:99]
    s_waitcnt lgkmcnt(0)
    v_mfma_f32_16x16x32_bf16 v[100:103], v[208:211], v[120:123], 0
    v_mfma_f32_16x16x32_bf16 v[100:103], v[212:215], v[124:127], v[100:103]
    v_add_u32 v5, s47, v5
    v_add_u32 v6, s47, v6
    v_add_u32 v8, s47, v8
    v_add_u32 v9, s47, v9
    v_add_u32 v10, s47, v10
    v_add_u32 v11, s47, v11
    s_nop 1
    v_and_b32 v104, v23, v88
    v_and_b32 v105, v23, v89
    v_and_b32 v106, v23, v90
    v_and_b32 v107, v23, v91
    v_and_b32 v108, v23, v92
    v_and_b32 v109, v23, v93
    v_and_b32 v110, v23, v94
    v_and_b32 v111, v23, v95
    v_and_b32 v112, v23, v96
    v_and_b32 v113, v23, v97
    v_and_b32 v114, v23, v98
    v_and_b32 v115, v23, v99
    v_and_b32 v116, v23, v100
    v_and_b32 v117, v23, v101
    v_and_b32 v118, v23, v102
    v_and_b32 v119, v23, v103
    v_sub_f32 v104, v88, v104
    v_sub_f32 v105, v89, v105
    v_sub_f32 v106, v90, v106
    v_sub_f32 v107, v91, v107
    v_sub_f32 v108, v92, v108
    v_sub_f32 v109, v93, v109
    v_sub_f32 v110, v94, v110
    v_sub_f32 v111, v95, v111
    v_sub_f32 v112, v96, v112
    v_sub_f32 v113, v97, v113
    v_sub_f32 v114, v98, v114
    v_sub_f32 v115, v99, v115
    v_sub_f32 v116, v100, v116
    v_sub_f32 v117, v101, v117
    v_sub_f32 v118, v102, v118
    v_sub_f32 v119, v103, v119
    v_perm_b32 v168, v105, v104, s43
    v_perm_b32 v169, v107, v106, s43
    v_perm_b32 v170, v109, v108, s43
    v_perm_b32 v171, v111, v110, s43
    v_perm_b32 v172, v113, v112, s43
    v_perm_b32 v173, v115, v114, s43
    v_perm_b32 v174, v117, v116, s43
    v_perm_b32 v175, v119, v118, s43
    s_barrier
    ds_read_b64_tr_b16 v[40:41], v5 offset:0
    ds_read_b64_tr_b16 v[42:43], v5 offset:4096
    ds_read_b64_tr_b16 v[44:45], v6 offset:0
    ds_read_b64_tr_b16 v[46:47], v6 offset:4096
    ds_read_b64_tr_b16 v[48:49], v5 offset:8192
    ds_read_b64_tr_b16 v[50:51], v5 offset:12288
    ds_read_b64_tr_b16 v[52:53], v6 offset:8192
    ds_read_b64_tr_b16 v[54:55], v6 offset:12288
    ds_read_b64_tr_b16 v[184:185], v8 offset:0
    ds_read_b64_tr_b16 v[186:187], v8 offset:2048
    ds_read_b64_tr_b16 v[188:189], v8 offset:4096
    ds_read_b64_tr_b16 v[190:191], v8 offset:6144
    s_waitcnt lgkmcnt(10)
    v_mfma_f32_16x16x32_bf16 v[128:131], v[40:43], v[168:171], v[128:131]
    s_waitcnt lgkmcnt(8)
    v_mfma_f32_16x16x32_bf16 v[132:135], v[44:47], v[168:171], v[132:135]
    s_waitcnt lgkmcnt(6)
    v_mfma_f32_16x16x32_bf16 v[128:131], v[48:51], v[172:175], v[128:131]
    s_waitcnt lgkmcnt(4)
    v_mfma_f32_16x16x32_bf16 v[132:135], v[52:55], v[172:175], v[132:135]
    ds_read_b64_tr_b16 v[192:193], v9 offset:0
    ds_read_b64_tr_b16 v[194:195], v9 offset:2048
    ds_read_b64_tr_b16 v[196:197], v9 offset:4096
    ds_read_b64_tr_b16 v[198:199], v9 offset:6144
    ds_read_b64_tr_b16 v[200:201], v10 offset:0
    ds_read_b64_tr_b16 v[202:203], v10 offset:2048
    ds_read_b64_tr_b16 v[204:205], v10 offset:4096
    ds_read_b64_tr_b16 v[206:207], v10 offset:6144
    s_waitcnt lgkmcnt(8)
    v_mfma_f32_16x16x32_bf16 v[88:91], v[184:187], v[120:123], 0
    v_mfma_f32_16x16x32_bf16 v[88:91], v[188:191], v[124:127], v[88:91]
    ds_read_b64_tr_b16 v[208:209], v11 offset:0
    ds_read_b64_tr_b16 v[210:211], v11 offset:2048
    ds_read_b64_tr_b16 v[212:213], v11 offset:4096
    ds_read_b64_tr_b16 v[214:215], v11 offset:6144
    s_waitcnt lgkmcnt(8)
    v_mfma_f32_16x16x32_bf16 v[92:95], v[192:195], v[120:123], 0
    v_mfma_f32_16x16x32_bf16 v[92:95], v[196:199], v[124:127], v[92:95]
    s_waitcnt lgkmcnt(4)
    v_mfma_f32_16x16x32_bf16 v[96:99], v[200:203], v[120:123], 0
    v_mfma_f32_16x16x32_bf16 v[96:99], v[204:207], v[124:127], v[96:99]
    s_waitcnt lgkmcnt(0)
    v_mfma_f32_16x16x32_bf16 v[100:103], v[208:211], v[120:123], 0
    v_mfma_f32_16x16x32_bf16 v[100:103], v[212:215], v[124:127], v[100:103]
    v_add_u32 v5, s46, v5
    v_add_u32 v6, s46, v6
    v_add_u32 v8, s46, v8
    v_add_u32 v9, s46, v9
    v_add_u32 v10, s46, v10
    v_add_u32 v11, s46, v11
    s_nop 1
    v_and_b32 v104, v23, v88
    v_and_b32 v105, v23, v89
    v_and_b32 v106, v23, v90
    v_and_b32 v107, v23, v91
    v_and_b32 v108, v23, v92
    v_and_b32 v109, v23, v93
    v_and_b32 v110, v23, v94
    v_and_b32 v111, v23, v95
    v_and_b32 v112, v23, v96
    v_and_b32 v113, v23, v97
    v_and_b32 v114, v23, v98
    v_and_b32 v115, v23, v99
    v_and_b32 v116, v23, v100
    v_and_b32 v117, v23, v101
    v_and_b32 v118, v23, v102
    v_and_b32 v119, v23, v103
    v_sub_f32 v104, v88, v104
    v_sub_f32 v105, v89, v105
    v_sub_f32 v106, v90, v106
    v_sub_f32 v107, v91, v107
    v_sub_f32 v108, v92, v108
    v_sub_f32 v109, v93, v109
    v_sub_f32 v110, v94, v110
    v_sub_f32 v111, v95, v111
    v_sub_f32 v112, v96, v112
    v_sub_f32 v113, v97, v113
    v_sub_f32 v114, v98, v114
    v_sub_f32 v115, v99, v115
    v_sub_f32 v116, v100, v116
    v_sub_f32 v117, v101, v117
    v_sub_f32 v118, v102, v118
    v_sub_f32 v119, v103, v119
    v_perm_b32 v176, v105, v104, s43
    v_perm_b32 v177, v107, v106, s43
    v_perm_b32 v178, v109, v108, s43
    v_perm_b32 v179, v111, v110, s43
    v_perm_b32 v180, v113, v112, s43
    v_perm_b32 v181, v115, v114, s43
    v_perm_b32 v182, v117, v116, s43
    v_perm_b32 v183, v119, v118, s43
    s_barrier
    ds_read_b64_tr_b16 v[40:41], v5 offset:0
    ds_read_b64_tr_b16 v[42:43], v5 offset:4096
    ds_read_b64_tr_b16 v[44:45], v6 offset:0
    ds_read_b64_tr_b16 v[46:47], v6 offset:4096
    ds_read_b64_tr_b16 v[48:49], v5 offset:8192
    ds_read_b64_tr_b16 v[50:51], v5 offset:12288
    ds_read_b64_tr_b16 v[52:53], v6 offset:8192
    ds_read_b64_tr_b16 v[54:55], v6 offset:12288
    ds_read_b64_tr_b16 v[184:185], v8 offset:0
    ds_read_b64_tr_b16 v[186:187], v8 offset:2048
    ds_read_b64_tr_b16 v[188:189], v8 offset:4096
    ds_read_b64_tr_b16 v[190:191], v8 offset:6144
    s_waitcnt lgkmcnt(10)
    v_mfma_f32_16x16x32_bf16 v[128:131], v[40:43], v[176:179], v[128:131]
    s_waitcnt lgkmcnt(8)
    v_mfma_f32_16x16x32_bf16 v[132:135], v[44:47], v[176:179], v[132:135]
    s_waitcnt lgkmcnt(6)
    v_mfma_f32_16x16x32_bf16 v[128:131], v[48:51], v[180:183], v[128:131]
    s_waitcnt lgkmcnt(4)
    v_mfma_f32_16x16x32_bf16 v[132:135], v[52:55], v[180:183], v[132:135]
    ds_read_b64_tr_b16 v[192:193], v9 offset:0
    ds_read_b64_tr_b16 v[194:195], v9 offset:2048
    ds_read_b64_tr_b16 v[196:197], v9 offset:4096
    ds_read_b64_tr_b16 v[198:199], v9 offset:6144
    ds_read_b64_tr_b16 v[200:201], v10 offset:0
    ds_read_b64_tr_b16 v[202:203], v10 offset:2048
    ds_read_b64_tr_b16 v[204:205], v10 offset:4096
    ds_read_b64_tr_b16 v[206:207], v10 offset:6144
    s_waitcnt lgkmcnt(8)
    v_mfma_f32_16x16x32_bf16 v[88:91], v[184:187], v[120:123], 0
    v_mfma_f32_16x16x32_bf16 v[88:91], v[188:191], v[124:127], v[88:91]
    ds_read_b64_tr_b16 v[208:209], v11 offset:0
    ds_read_b64_tr_b16 v[210:211], v11 offset:2048
    ds_read_b64_tr_b16 v[212:213], v11 offset:4096
    ds_read_b64_tr_b16 v[214:215], v11 offset:6144
    s_waitcnt lgkmcnt(8)
    v_mfma_f32_16x16x32_bf16 v[92:95], v[192:195], v[120:123], 0
    v_mfma_f32_16x16x32_bf16 v[92:95], v[196:199], v[124:127], v[92:95]
    s_waitcnt lgkmcnt(4)
    v_mfma_f32_16x16x32_bf16 v[96:99], v[200:203], v[120:123], 0
    v_mfma_f32_16x16x32_bf16 v[96:99], v[204:207], v[124:127], v[96:99]
    s_waitcnt lgkmcnt(0)
    v_mfma_f32_16x16x32_bf16 v[100:103], v[208:211], v[120:123], 0
    v_mfma_f32_16x16x32_bf16 v[100:103], v[212:215], v[124:127], v[100:103]
    v_add_u32 v5, s46, v5
    v_add_u32 v6, s46, v6
    v_add_u32 v8, s46, v8
    v_add_u32 v9, s46, v9
    v_add_u32 v10, s46, v10
    v_add_u32 v11, s46, v11
    s_nop 1
    v_and_b32 v104, v23, v88
    v_and_b32 v105, v23, v89
    v_and_b32 v106, v23, v90
    v_and_b32 v107, v23, v91
    v_and_b32 v108, v23, v92
    v_and_b32 v109, v23, v93
    v_and_b32 v110, v23, v94
    v_and_b32 v111, v23, v95
    v_and_b32 v112, v23, v96
    v_and_b32 v113, v23, v97
    v_and_b32 v114, v23, v98
    v_and_b32 v115, v23, v99
    v_and_b32 v116, v23, v100
    v_and_b32 v117, v23, v101
    v_and_b32 v118, v23, v102
    v_and_b32 v119, v23, v103
    v_sub_f32 v104, v88, v104
    v_sub_f32 v105, v89, v105
    v_sub_f32 v106, v90, v106
    v_sub_f32 v107, v91, v107
    v_sub_f32 v108, v92, v108
    v_sub_f32 v109, v93, v109
    v_sub_f32 v110, v94, v110
    v_sub_f32 v111, v95, v111
    v_sub_f32 v112, v96, v112
    v_sub_f32 v113, v97, v113
    v_sub_f32 v114, v98, v114
    v_sub_f32 v115, v99, v115
    v_sub_f32 v116, v100, v116
    v_sub_f32 v117, v101, v117
    v_sub_f32 v118, v102, v118
    v_sub_f32 v119, v103, v119
    v_perm_b32 v168, v105, v104, s43
    v_perm_b32 v169, v107, v106, s43
    v_perm_b32 v170, v109, v108, s43
    v_perm_b32 v171, v111, v110, s43
    v_perm_b32 v172, v113, v112, s43
    v_perm_b32 v173, v115, v114, s43
    v_perm_b32 v174, v117, v116, s43
    v_perm_b32 v175, v119, v118, s43
    s_barrier
    ds_read_b64_tr_b16 v[40:41], v5 offset:0
    ds_read_b64_tr_b16 v[42:43], v5 offset:4096
    ds_read_b64_tr_b16 v[44:45], v6 offset:0
    ds_read_b64_tr_b16 v[46:47], v6 offset:4096
    ds_read_b64_tr_b16 v[48:49], v5 offset:8192
    ds_read_b64_tr_b16 v[50:51], v5 offset:12288
    ds_read_b64_tr_b16 v[52:53], v6 offset:8192
    ds_read_b64_tr_b16 v[54:55], v6 offset:12288
    ds_read_b64_tr_b16 v[184:185], v8 offset:0
    ds_read_b64_tr_b16 v[186:187], v8 offset:2048
    ds_read_b64_tr_b16 v[188:189], v8 offset:4096
    ds_read_b64_tr_b16 v[190:191], v8 offset:6144
    s_waitcnt lgkmcnt(10)
    v_mfma_f32_16x16x32_bf16 v[128:131], v[40:43], v[168:171], v[128:131]
    s_waitcnt lgkmcnt(8)
    v_mfma_f32_16x16x32_bf16 v[132:135], v[44:47], v[168:171], v[132:135]
    s_waitcnt lgkmcnt(6)
    v_mfma_f32_16x16x32_bf16 v[128:131], v[48:51], v[172:175], v[128:131]
    s_waitcnt lgkmcnt(4)
    v_mfma_f32_16x16x32_bf16 v[132:135], v[52:55], v[172:175], v[132:135]
    ds_read_b64_tr_b16 v[192:193], v9 offset:0
    ds_read_b64_tr_b16 v[194:195], v9 offset:2048
    ds_read_b64_tr_b16 v[196:197], v9 offset:4096
    ds_read_b64_tr_b16 v[198:199], v9 offset:6144
    ds_read_b64_tr_b16 v[200:201], v10 offset:0
    ds_read_b64_tr_b16 v[202:203], v10 offset:2048
    ds_read_b64_tr_b16 v[204:205], v10 offset:4096
    ds_read_b64_tr_b16 v[206:207], v10 offset:6144
    s_waitcnt lgkmcnt(8)
    v_mfma_f32_16x16x32_bf16 v[88:91], v[184:187], v[120:123], 0
    v_mfma_f32_16x16x32_bf16 v[88:91], v[188:191], v[124:127], v[88:91]
    ds_read_b64_tr_b16 v[208:209], v11 offset:0
    ds_read_b64_tr_b16 v[210:211], v11 offset:2048
    ds_read_b64_tr_b16 v[212:213], v11 offset:4096
    ds_read_b64_tr_b16 v[214:215], v11 offset:6144
    s_waitcnt lgkmcnt(8)
    v_mfma_f32_16x16x32_bf16 v[92:95], v[192:195], v[120:123], 0
    v_mfma_f32_16x16x32_bf16 v[92:95], v[196:199], v[124:127], v[92:95]
    s_waitcnt lgkmcnt(4)
    v_mfma_f32_16x16x32_bf16 v[96:99], v[200:203], v[120:123], 0
    v_mfma_f32_16x16x32_bf16 v[96:99], v[204:207], v[124:127], v[96:99]
    s_waitcnt lgkmcnt(0)
    v_mfma_f32_16x16x32_bf16 v[100:103], v[208:211], v[120:123], 0
    v_mfma_f32_16x16x32_bf16 v[100:103], v[212:215], v[124:127], v[100:103]
    v_add_u32 v5, s46, v5
    v_add_u32 v6, s46, v6
    v_add_u32 v8, s46, v8
    v_add_u32 v9, s46, v9
    v_add_u32 v10, s46, v10
    v_add_u32 v11, s46, v11
    s_nop 1
    v_and_b32 v104, v23, v88
    v_and_b32 v105, v23, v89
    v_and_b32 v106, v23, v90
    v_and_b32 v107, v23, v91
    v_and_b32 v108, v23, v92
    v_and_b32 v109, v23, v93
    v_and_b32 v110, v23, v94
    v_and_b32 v111, v23, v95
    v_and_b32 v112, v23, v96
    v_and_b32 v113, v23, v97
    v_and_b32 v114, v23, v98
    v_and_b32 v115, v23, v99
    v_and_b32 v116, v23, v100
    v_and_b32 v117, v23, v101
    v_and_b32 v118, v23, v102
    v_and_b32 v119, v23, v103
    v_sub_f32 v104, v88, v104
    v_sub_f32 v105, v89, v105
    v_sub_f32 v106, v90, v106
    v_sub_f32 v107, v91, v107
    v_sub_f32 v108, v92, v108
    v_sub_f32 v109, v93, v109
    v_sub_f32 v110, v94, v110
    v_sub_f32 v111, v95, v111
    v_sub_f32 v112, v96, v112
    v_sub_f32 v113, v97, v113
    v_sub_f32 v114, v98, v114
    v_sub_f32 v115, v99, v115
    v_sub_f32 v116, v100, v116
    v_sub_f32 v117, v101, v117
    v_sub_f32 v118, v102, v118
    v_sub_f32 v119, v103, v119
    v_perm_b32 v176, v105, v104, s43
    v_perm_b32 v177, v107, v106, s43
    v_perm_b32 v178, v109, v108, s43
    v_perm_b32 v179, v111, v110, s43
    v_perm_b32 v180, v113, v112, s43
    v_perm_b32 v181, v115, v114, s43
    v_perm_b32 v182, v117, v116, s43
    v_perm_b32 v183, v119, v118, s43
    s_barrier
    ds_read_b64_tr_b16 v[40:41], v5 offset:0
    ds_read_b64_tr_b16 v[42:43], v5 offset:4096
    ds_read_b64_tr_b16 v[44:45], v6 offset:0
    ds_read_b64_tr_b16 v[46:47], v6 offset:4096
    ds_read_b64_tr_b16 v[48:49], v5 offset:8192
    ds_read_b64_tr_b16 v[50:51], v5 offset:12288
    ds_read_b64_tr_b16 v[52:53], v6 offset:8192
    ds_read_b64_tr_b16 v[54:55], v6 offset:12288
    ds_read_b64_tr_b16 v[184:185], v8 offset:0
    ds_read_b64_tr_b16 v[186:187], v8 offset:2048
    ds_read_b64_tr_b16 v[188:189], v8 offset:4096
    ds_read_b64_tr_b16 v[190:191], v8 offset:6144
    s_waitcnt lgkmcnt(10)
    v_mfma_f32_16x16x32_bf16 v[128:131], v[40:43], v[176:179], v[128:131]
    s_waitcnt lgkmcnt(8)
    v_mfma_f32_16x16x32_bf16 v[132:135], v[44:47], v[176:179], v[132:135]
    s_waitcnt lgkmcnt(6)
    v_mfma_f32_16x16x32_bf16 v[128:131], v[48:51], v[180:183], v[128:131]
    s_waitcnt lgkmcnt(4)
    v_mfma_f32_16x16x32_bf16 v[132:135], v[52:55], v[180:183], v[132:135]
    ds_read_b64_tr_b16 v[192:193], v9 offset:0
    ds_read_b64_tr_b16 v[194:195], v9 offset:2048
    ds_read_b64_tr_b16 v[196:197], v9 offset:4096
    ds_read_b64_tr_b16 v[198:199], v9 offset:6144
    ds_read_b64_tr_b16 v[200:201], v10 offset:0
    ds_read_b64_tr_b16 v[202:203], v10 offset:2048
    ds_read_b64_tr_b16 v[204:205], v10 offset:4096
    ds_read_b64_tr_b16 v[206:207], v10 offset:6144
    s_waitcnt lgkmcnt(8)
    v_mfma_f32_16x16x32_bf16 v[88:91], v[184:187], v[120:123], 0
    v_mfma_f32_16x16x32_bf16 v[88:91], v[188:191], v[124:127], v[88:91]
    ds_read_b64_tr_b16 v[208:209], v11 offset:0
    ds_read_b64_tr_b16 v[210:211], v11 offset:2048
    ds_read_b64_tr_b16 v[212:213], v11 offset:4096
    ds_read_b64_tr_b16 v[214:215], v11 offset:6144
    s_waitcnt lgkmcnt(8)
    v_mfma_f32_16x16x32_bf16 v[92:95], v[192:195], v[120:123], 0
    v_mfma_f32_16x16x32_bf16 v[92:95], v[196:199], v[124:127], v[92:95]
    s_waitcnt lgkmcnt(4)
    v_mfma_f32_16x16x32_bf16 v[96:99], v[200:203], v[120:123], 0
    v_mfma_f32_16x16x32_bf16 v[96:99], v[204:207], v[124:127], v[96:99]
    s_waitcnt lgkmcnt(0)
    v_mfma_f32_16x16x32_bf16 v[100:103], v[208:211], v[120:123], 0
    v_mfma_f32_16x16x32_bf16 v[100:103], v[212:215], v[124:127], v[100:103]
    v_add_u32 v5, s46, v5
    v_add_u32 v6, s46, v6
    v_add_u32 v8, s46, v8
    v_add_u32 v9, s46, v9
    v_add_u32 v10, s46, v10
    v_add_u32 v11, s46, v11
    s_nop 1
    v_and_b32 v104, v23, v88
    v_and_b32 v105, v23, v89
    v_and_b32 v106, v23, v90
    v_and_b32 v107, v23, v91
    v_and_b32 v108, v23, v92
    v_and_b32 v109, v23, v93
    v_and_b32 v110, v23, v94
    v_and_b32 v111, v23, v95
    v_and_b32 v112, v23, v96
    v_and_b32 v113, v23, v97
    v_and_b32 v114, v23, v98
    v_and_b32 v115, v23, v99
    v_and_b32 v116, v23, v100
    v_and_b32 v117, v23, v101
    v_and_b32 v118, v23, v102
    v_and_b32 v119, v23, v103
    v_sub_f32 v104, v88, v104
    v_sub_f32 v105, v89, v105
    v_sub_f32 v106, v90, v106
    v_sub_f32 v107, v91, v107
    v_sub_f32 v108, v92, v108
    v_sub_f32 v109, v93, v109
    v_sub_f32 v110, v94, v110
    v_sub_f32 v111, v95, v111
    v_sub_f32 v112, v96, v112
    v_sub_f32 v113, v97, v113
    v_sub_f32 v114, v98, v114
    v_sub_f32 v115, v99, v115
    v_sub_f32 v116, v100, v116
    v_sub_f32 v117, v101, v117
    v_sub_f32 v118, v102, v118
    v_sub_f32 v119, v103, v119
    v_perm_b32 v168, v105, v104, s43
    v_perm_b32 v169, v107, v106, s43
    v_perm_b32 v170, v109, v108, s43
    v_perm_b32 v171, v111, v110, s43
    v_perm_b32 v172, v113, v112, s43
    v_perm_b32 v173, v115, v114, s43
    v_perm_b32 v174, v117, v116, s43
    v_perm_b32 v175, v119, v118, s43
    s_barrier
    ds_read_b64_tr_b16 v[40:41], v5 offset:0
    ds_read_b64_tr_b16 v[42:43], v5 offset:4096
    ds_read_b64_tr_b16 v[44:45], v6 offset:0
    ds_read_b64_tr_b16 v[46:47], v6 offset:4096
    ds_read_b64_tr_b16 v[48:49], v5 offset:8192
    ds_read_b64_tr_b16 v[50:51], v5 offset:12288
    ds_read_b64_tr_b16 v[52:53], v6 offset:8192
    ds_read_b64_tr_b16 v[54:55], v6 offset:12288
    ds_read_b64_tr_b16 v[184:185], v8 offset:0
    ds_read_b64_tr_b16 v[186:187], v8 offset:2048
    ds_read_b64_tr_b16 v[188:189], v8 offset:4096
    ds_read_b64_tr_b16 v[190:191], v8 offset:6144
    s_waitcnt lgkmcnt(10)
    v_mfma_f32_16x16x32_bf16 v[128:131], v[40:43], v[168:171], v[128:131]
    s_waitcnt lgkmcnt(8)
    v_mfma_f32_16x16x32_bf16 v[132:135], v[44:47], v[168:171], v[132:135]
    s_waitcnt lgkmcnt(6)
    v_mfma_f32_16x16x32_bf16 v[128:131], v[48:51], v[172:175], v[128:131]
    s_waitcnt lgkmcnt(4)
    v_mfma_f32_16x16x32_bf16 v[132:135], v[52:55], v[172:175], v[132:135]
    ds_read_b64_tr_b16 v[192:193], v9 offset:0
    ds_read_b64_tr_b16 v[194:195], v9 offset:2048
    ds_read_b64_tr_b16 v[196:197], v9 offset:4096
    ds_read_b64_tr_b16 v[198:199], v9 offset:6144
    ds_read_b64_tr_b16 v[200:201], v10 offset:0
    ds_read_b64_tr_b16 v[202:203], v10 offset:2048
    ds_read_b64_tr_b16 v[204:205], v10 offset:4096
    ds_read_b64_tr_b16 v[206:207], v10 offset:6144
    s_waitcnt lgkmcnt(8)
    v_mfma_f32_16x16x32_bf16 v[88:91], v[184:187], v[120:123], 0
    v_mfma_f32_16x16x32_bf16 v[88:91], v[188:191], v[124:127], v[88:91]
    ds_read_b64_tr_b16 v[208:209], v11 offset:0
    ds_read_b64_tr_b16 v[210:211], v11 offset:2048
    ds_read_b64_tr_b16 v[212:213], v11 offset:4096
    ds_read_b64_tr_b16 v[214:215], v11 offset:6144
    s_waitcnt lgkmcnt(8)
    v_mfma_f32_16x16x32_bf16 v[92:95], v[192:195], v[120:123], 0
    v_mfma_f32_16x16x32_bf16 v[92:95], v[196:199], v[124:127], v[92:95]
    s_waitcnt lgkmcnt(4)
    v_mfma_f32_16x16x32_bf16 v[96:99], v[200:203], v[120:123], 0
    v_mfma_f32_16x16x32_bf16 v[96:99], v[204:207], v[124:127], v[96:99]
    s_waitcnt lgkmcnt(0)
    v_mfma_f32_16x16x32_bf16 v[100:103], v[208:211], v[120:123], 0
    v_mfma_f32_16x16x32_bf16 v[100:103], v[212:215], v[124:127], v[100:103]
    v_add_u32 v5, s46, v5
    v_add_u32 v6, s46, v6
    v_add_u32 v8, s46, v8
    v_add_u32 v9, s46, v9
    v_add_u32 v10, s46, v10
    v_add_u32 v11, s46, v11
    s_nop 1
    v_and_b32 v104, v23, v88
    v_and_b32 v105, v23, v89
    v_and_b32 v106, v23, v90
    v_and_b32 v107, v23, v91
    v_and_b32 v108, v23, v92
    v_and_b32 v109, v23, v93
    v_and_b32 v110, v23, v94
    v_and_b32 v111, v23, v95
    v_and_b32 v112, v23, v96
    v_and_b32 v113, v23, v97
    v_and_b32 v114, v23, v98
    v_and_b32 v115, v23, v99
    v_and_b32 v116, v23, v100
    v_and_b32 v117, v23, v101
    v_and_b32 v118, v23, v102
    v_and_b32 v119, v23, v103
    v_sub_f32 v104, v88, v104
    v_sub_f32 v105, v89, v105
    v_sub_f32 v106, v90, v106
    v_sub_f32 v107, v91, v107
    v_sub_f32 v108, v92, v108
    v_sub_f32 v109, v93, v109
    v_sub_f32 v110, v94, v110
    v_sub_f32 v111, v95, v111
    v_sub_f32 v112, v96, v112
    v_sub_f32 v113, v97, v113
    v_sub_f32 v114, v98, v114
    v_sub_f32 v115, v99, v115
    v_sub_f32 v116, v100, v116
    v_sub_f32 v117, v101, v117
    v_sub_f32 v118, v102, v118
    v_sub_f32 v119, v103, v119
    v_perm_b32 v176, v105, v104, s43
    v_perm_b32 v177, v107, v106, s43
    v_perm_b32 v178, v109, v108, s43
    v_perm_b32 v179, v111, v110, s43
    v_perm_b32 v180, v113, v112, s43
    v_perm_b32 v181, v115, v114, s43
    v_perm_b32 v182, v117, v116, s43
    v_perm_b32 v183, v119, v118, s43
    s_barrier
    ds_read_b64_tr_b16 v[40:41], v5 offset:0
    ds_read_b64_tr_b16 v[42:43], v5 offset:4096
    ds_read_b64_tr_b16 v[44:45], v6 offset:0
    ds_read_b64_tr_b16 v[46:47], v6 offset:4096
    ds_read_b64_tr_b16 v[48:49], v5 offset:8192
    ds_read_b64_tr_b16 v[50:51], v5 offset:12288
    ds_read_b64_tr_b16 v[52:53], v6 offset:8192
    ds_read_b64_tr_b16 v[54:55], v6 offset:12288
    ds_read_b64_tr_b16 v[184:185], v8 offset:0
    ds_read_b64_tr_b16 v[186:187], v8 offset:2048
    ds_read_b64_tr_b16 v[188:189], v8 offset:4096
    ds_read_b64_tr_b16 v[190:191], v8 offset:6144
    s_waitcnt lgkmcnt(10)
    v_mfma_f32_16x16x32_bf16 v[128:131], v[40:43], v[176:179], v[128:131]
    s_waitcnt lgkmcnt(8)
    v_mfma_f32_16x16x32_bf16 v[132:135], v[44:47], v[176:179], v[132:135]
    s_waitcnt lgkmcnt(6)
    v_mfma_f32_16x16x32_bf16 v[128:131], v[48:51], v[180:183], v[128:131]
    s_waitcnt lgkmcnt(4)
    v_mfma_f32_16x16x32_bf16 v[132:135], v[52:55], v[180:183], v[132:135]
    ds_read_b64_tr_b16 v[192:193], v9 offset:0
    ds_read_b64_tr_b16 v[194:195], v9 offset:2048
    ds_read_b64_tr_b16 v[196:197], v9 offset:4096
    ds_read_b64_tr_b16 v[198:199], v9 offset:6144
    ds_read_b64_tr_b16 v[200:201], v10 offset:0
    ds_read_b64_tr_b16 v[202:203], v10 offset:2048
    ds_read_b64_tr_b16 v[204:205], v10 offset:4096
    ds_read_b64_tr_b16 v[206:207], v10 offset:6144
    s_waitcnt lgkmcnt(8)
    v_mfma_f32_16x16x32_bf16 v[88:91], v[184:187], v[120:123], 0
    v_mfma_f32_16x16x32_bf16 v[88:91], v[188:191], v[124:127], v[88:91]
    ds_read_b64_tr_b16 v[208:209], v11 offset:0
    ds_read_b64_tr_b16 v[210:211], v11 offset:2048
    ds_read_b64_tr_b16 v[212:213], v11 offset:4096
    ds_read_b64_tr_b16 v[214:215], v11 offset:6144
    s_waitcnt lgkmcnt(8)
    v_mfma_f32_16x16x32_bf16 v[92:95], v[192:195], v[120:123], 0
    v_mfma_f32_16x16x32_bf16 v[92:95], v[196:199], v[124:127], v[92:95]
    s_waitcnt lgkmcnt(4)
    v_mfma_f32_16x16x32_bf16 v[96:99], v[200:203], v[120:123], 0
    v_mfma_f32_16x16x32_bf16 v[96:99], v[204:207], v[124:127], v[96:99]
    s_waitcnt lgkmcnt(0)
    v_mfma_f32_16x16x32_bf16 v[100:103], v[208:211], v[120:123], 0
    v_mfma_f32_16x16x32_bf16 v[100:103], v[212:215], v[124:127], v[100:103]
    v_add_u32 v5, s47, v5
    v_add_u32 v6, s47, v6
    v_add_u32 v8, s47, v8
    v_add_u32 v9, s47, v9
    v_add_u32 v10, s47, v10
    v_add_u32 v11, s47, v11
    s_nop 1
    v_and_b32 v104, v23, v88
    v_and_b32 v105, v23, v89
    v_and_b32 v106, v23, v90
    v_and_b32 v107, v23, v91
    v_and_b32 v108, v23, v92
    v_and_b32 v109, v23, v93
    v_and_b32 v110, v23, v94
    v_and_b32 v111, v23, v95
    v_and_b32 v112, v23, v96
    v_and_b32 v113, v23, v97
    v_and_b32 v114, v23, v98
    v_and_b32 v115, v23, v99
    v_and_b32 v116, v23, v100
    v_and_b32 v117, v23, v101
    v_and_b32 v118, v23, v102
    v_and_b32 v119, v23, v103
    v_sub_f32 v104, v88, v104
    v_sub_f32 v105, v89, v105
    v_sub_f32 v106, v90, v106
    v_sub_f32 v107, v91, v107
    v_sub_f32 v108, v92, v108
    v_sub_f32 v109, v93, v109
    v_sub_f32 v110, v94, v110
    v_sub_f32 v111, v95, v111
    v_sub_f32 v112, v96, v112
    v_sub_f32 v113, v97, v113
    v_sub_f32 v114, v98, v114
    v_sub_f32 v115, v99, v115
    v_sub_f32 v116, v100, v116
    v_sub_f32 v117, v101, v117
    v_sub_f32 v118, v102, v118
    v_sub_f32 v119, v103, v119
    v_perm_b32 v168, v105, v104, s43
    v_perm_b32 v169, v107, v106, s43
    v_perm_b32 v170, v109, v108, s43
    v_perm_b32 v171, v111, v110, s43
    v_perm_b32 v172, v113, v112, s43
    v_perm_b32 v173, v115, v114, s43
    v_perm_b32 v174, v117, v116, s43
    v_perm_b32 v175, v119, v118, s43
    s_barrier
    ds_read_b64_tr_b16 v[40:41], v5 offset:0
    ds_read_b64_tr_b16 v[42:43], v5 offset:4096
    ds_read_b64_tr_b16 v[44:45], v6 offset:0
    ds_read_b64_tr_b16 v[46:47], v6 offset:4096
    ds_read_b64_tr_b16 v[48:49], v5 offset:8192
    ds_read_b64_tr_b16 v[50:51], v5 offset:12288
    ds_read_b64_tr_b16 v[52:53], v6 offset:8192
    ds_read_b64_tr_b16 v[54:55], v6 offset:12288
    ds_read_b64_tr_b16 v[184:185], v8 offset:0
    ds_read_b64_tr_b16 v[186:187], v8 offset:2048
    ds_read_b64_tr_b16 v[188:189], v8 offset:4096
    ds_read_b64_tr_b16 v[190:191], v8 offset:6144
    s_waitcnt lgkmcnt(10)
    v_mfma_f32_16x16x32_bf16 v[128:131], v[40:43], v[168:171], v[128:131]
    s_waitcnt lgkmcnt(8)
    v_mfma_f32_16x16x32_bf16 v[132:135], v[44:47], v[168:171], v[132:135]
    s_waitcnt lgkmcnt(6)
    v_mfma_f32_16x16x32_bf16 v[128:131], v[48:51], v[172:175], v[128:131]
    s_waitcnt lgkmcnt(4)
    v_mfma_f32_16x16x32_bf16 v[132:135], v[52:55], v[172:175], v[132:135]
    ds_read_b64_tr_b16 v[192:193], v9 offset:0
    ds_read_b64_tr_b16 v[194:195], v9 offset:2048
    ds_read_b64_tr_b16 v[196:197], v9 offset:4096
    ds_read_b64_tr_b16 v[198:199], v9 offset:6144
    ds_read_b64_tr_b16 v[200:201], v10 offset:0
    ds_read_b64_tr_b16 v[202:203], v10 offset:2048
    ds_read_b64_tr_b16 v[204:205], v10 offset:4096
    ds_read_b64_tr_b16 v[206:207], v10 offset:6144
    s_waitcnt lgkmcnt(8)
    v_mfma_f32_16x16x32_bf16 v[88:91], v[184:187], v[120:123], 0
    v_mfma_f32_16x16x32_bf16 v[88:91], v[188:191], v[124:127], v[88:91]
    ds_read_b64_tr_b16 v[208:209], v11 offset:0
    ds_read_b64_tr_b16 v[210:211], v11 offset:2048
    ds_read_b64_tr_b16 v[212:213], v11 offset:4096
    ds_read_b64_tr_b16 v[214:215], v11 offset:6144
    s_waitcnt lgkmcnt(8)
    v_mfma_f32_16x16x32_bf16 v[92:95], v[192:195], v[120:123], 0
    v_mfma_f32_16x16x32_bf16 v[92:95], v[196:199], v[124:127], v[92:95]
    s_waitcnt lgkmcnt(4)
    v_mfma_f32_16x16x32_bf16 v[96:99], v[200:203], v[120:123], 0
    v_mfma_f32_16x16x32_bf16 v[96:99], v[204:207], v[124:127], v[96:99]
    s_waitcnt lgkmcnt(0)
    v_mfma_f32_16x16x32_bf16 v[100:103], v[208:211], v[120:123], 0
    v_mfma_f32_16x16x32_bf16 v[100:103], v[212:215], v[124:127], v[100:103]
    v_add_u32 v5, s46, v5
    v_add_u32 v6, s46, v6
    v_add_u32 v8, s46, v8
    v_add_u32 v9, s46, v9
    v_add_u32 v10, s46, v10
    v_add_u32 v11, s46, v11
    s_nop 1
    v_and_b32 v104, v23, v88
    v_and_b32 v105, v23, v89
    v_and_b32 v106, v23, v90
    v_and_b32 v107, v23, v91
    v_and_b32 v108, v23, v92
    v_and_b32 v109, v23, v93
    v_and_b32 v110, v23, v94
    v_and_b32 v111, v23, v95
    v_and_b32 v112, v23, v96
    v_and_b32 v113, v23, v97
    v_and_b32 v114, v23, v98
    v_and_b32 v115, v23, v99
    v_and_b32 v116, v23, v100
    v_and_b32 v117, v23, v101
    v_and_b32 v118, v23, v102
    v_and_b32 v119, v23, v103
    v_sub_f32 v104, v88, v104
    v_sub_f32 v105, v89, v105
    v_sub_f32 v106, v90, v106
    v_sub_f32 v107, v91, v107
    v_sub_f32 v108, v92, v108
    v_sub_f32 v109, v93, v109
    v_sub_f32 v110, v94, v110
    v_sub_f32 v111, v95, v111
    v_sub_f32 v112, v96, v112
    v_sub_f32 v113, v97, v113
    v_sub_f32 v114, v98, v114
    v_sub_f32 v115, v99, v115
    v_sub_f32 v116, v100, v116
    v_sub_f32 v117, v101, v117
    v_sub_f32 v118, v102, v118
    v_sub_f32 v119, v103, v119
    v_perm_b32 v176, v105, v104, s43
    v_perm_b32 v177, v107, v106, s43
    v_perm_b32 v178, v109, v108, s43
    v_perm_b32 v179, v111, v110, s43
    v_perm_b32 v180, v113, v112, s43
    v_perm_b32 v181, v115, v114, s43
    v_perm_b32 v182, v117, v116, s43
    v_perm_b32 v183, v119, v118, s43
    s_barrier
    ds_read_b64_tr_b16 v[40:41], v5 offset:0
    ds_read_b64_tr_b16 v[42:43], v5 offset:4096
    ds_read_b64_tr_b16 v[44:45], v6 offset:0
    ds_read_b64_tr_b16 v[46:47], v6 offset:4096
    ds_read_b64_tr_b16 v[48:49], v5 offset:8192
    ds_read_b64_tr_b16 v[50:51], v5 offset:12288
    ds_read_b64_tr_b16 v[52:53], v6 offset:8192
    ds_read_b64_tr_b16 v[54:55], v6 offset:12288
    ds_read_b64_tr_b16 v[184:185], v8 offset:0
    ds_read_b64_tr_b16 v[186:187], v8 offset:2048
    ds_read_b64_tr_b16 v[188:189], v8 offset:4096
    ds_read_b64_tr_b16 v[190:191], v8 offset:6144
    s_waitcnt lgkmcnt(10)
    v_mfma_f32_16x16x32_bf16 v[128:131], v[40:43], v[176:179], v[128:131]
    s_waitcnt lgkmcnt(8)
    v_mfma_f32_16x16x32_bf16 v[132:135], v[44:47], v[176:179], v[132:135]
    s_waitcnt lgkmcnt(6)
    v_mfma_f32_16x16x32_bf16 v[128:131], v[48:51], v[180:183], v[128:131]
    s_waitcnt lgkmcnt(4)
    v_mfma_f32_16x16x32_bf16 v[132:135], v[52:55], v[180:183], v[132:135]
    ds_read_b64_tr_b16 v[192:193], v9 offset:0
    ds_read_b64_tr_b16 v[194:195], v9 offset:2048
    ds_read_b64_tr_b16 v[196:197], v9 offset:4096
    ds_read_b64_tr_b16 v[198:199], v9 offset:6144
    ds_read_b64_tr_b16 v[200:201], v10 offset:0
    ds_read_b64_tr_b16 v[202:203], v10 offset:2048
    ds_read_b64_tr_b16 v[204:205], v10 offset:4096
    ds_read_b64_tr_b16 v[206:207], v10 offset:6144
    s_waitcnt lgkmcnt(8)
    v_mfma_f32_16x16x32_bf16 v[88:91], v[184:187], v[120:123], 0
    v_mfma_f32_16x16x32_bf16 v[88:91], v[188:191], v[124:127], v[88:91]
    ds_read_b64_tr_b16 v[208:209], v11 offset:0
    ds_read_b64_tr_b16 v[210:211], v11 offset:2048
    ds_read_b64_tr_b16 v[212:213], v11 offset:4096
    ds_read_b64_tr_b16 v[214:215], v11 offset:6144
    s_waitcnt lgkmcnt(8)
    v_mfma_f32_16x16x32_bf16 v[92:95], v[192:195], v[120:123], 0
    v_mfma_f32_16x16x32_bf16 v[92:95], v[196:199], v[124:127], v[92:95]
    s_waitcnt lgkmcnt(4)
    v_mfma_f32_16x16x32_bf16 v[96:99], v[200:203], v[120:123], 0
    v_mfma_f32_16x16x32_bf16 v[96:99], v[204:207], v[124:127], v[96:99]
    s_waitcnt lgkmcnt(0)
    v_mfma_f32_16x16x32_bf16 v[100:103], v[208:211], v[120:123], 0
    v_mfma_f32_16x16x32_bf16 v[100:103], v[212:215], v[124:127], v[100:103]
    v_add_u32 v5, s46, v5
    v_add_u32 v6, s46, v6
    v_add_u32 v8, s46, v8
    v_add_u32 v9, s46, v9
    v_add_u32 v10, s46, v10
    v_add_u32 v11, s46, v11
    s_nop 1
    v_and_b32 v104, v23, v88
    v_and_b32 v105, v23, v89
    v_and_b32 v106, v23, v90
    v_and_b32 v107, v23, v91
    v_and_b32 v108, v23, v92
    v_and_b32 v109, v23, v93
    v_and_b32 v110, v23, v94
    v_and_b32 v111, v23, v95
    v_and_b32 v112, v23, v96
    v_and_b32 v113, v23, v97
    v_and_b32 v114, v23, v98
    v_and_b32 v115, v23, v99
    v_and_b32 v116, v23, v100
    v_and_b32 v117, v23, v101
    v_and_b32 v118, v23, v102
    v_and_b32 v119, v23, v103
    v_sub_f32 v104, v88, v104
    v_sub_f32 v105, v89, v105
    v_sub_f32 v106, v90, v106
    v_sub_f32 v107, v91, v107
    v_sub_f32 v108, v92, v108
    v_sub_f32 v109, v93, v109
    v_sub_f32 v110, v94, v110
    v_sub_f32 v111, v95, v111
    v_sub_f32 v112, v96, v112
    v_sub_f32 v113, v97, v113
    v_sub_f32 v114, v98, v114
    v_sub_f32 v115, v99, v115
    v_sub_f32 v116, v100, v116
    v_sub_f32 v117, v101, v117
    v_sub_f32 v118, v102, v118
    v_sub_f32 v119, v103, v119
    v_perm_b32 v168, v105, v104, s43
    v_perm_b32 v169, v107, v106, s43
    v_perm_b32 v170, v109, v108, s43
    v_perm_b32 v171, v111, v110, s43
    v_perm_b32 v172, v113, v112, s43
    v_perm_b32 v173, v115, v114, s43
    v_perm_b32 v174, v117, v116, s43
    v_perm_b32 v175, v119, v118, s43
    s_barrier
    ds_read_b64_tr_b16 v[40:41], v5 offset:0
    ds_read_b64_tr_b16 v[42:43], v5 offset:4096
    ds_read_b64_tr_b16 v[44:45], v6 offset:0
    ds_read_b64_tr_b16 v[46:47], v6 offset:4096
    ds_read_b64_tr_b16 v[48:49], v5 offset:8192
    ds_read_b64_tr_b16 v[50:51], v5 offset:12288
    ds_read_b64_tr_b16 v[52:53], v6 offset:8192
    ds_read_b64_tr_b16 v[54:55], v6 offset:12288
    ds_read_b64_tr_b16 v[184:185], v8 offset:0
    ds_read_b64_tr_b16 v[186:187], v8 offset:2048
    ds_read_b64_tr_b16 v[188:189], v8 offset:4096
    ds_read_b64_tr_b16 v[190:191], v8 offset:6144
    s_waitcnt lgkmcnt(10)
    v_mfma_f32_16x16x32_bf16 v[128:131], v[40:43], v[168:171], v[128:131]
    s_waitcnt lgkmcnt(8)
    v_mfma_f32_16x16x32_bf16 v[132:135], v[44:47], v[168:171], v[132:135]
    s_waitcnt lgkmcnt(6)
    v_mfma_f32_16x16x32_bf16 v[128:131], v[48:51], v[172:175], v[128:131]
    s_waitcnt lgkmcnt(4)
    v_mfma_f32_16x16x32_bf16 v[132:135], v[52:55], v[172:175], v[132:135]
    ds_read_b64_tr_b16 v[192:193], v9 offset:0
    ds_read_b64_tr_b16 v[194:195], v9 offset:2048
    ds_read_b64_tr_b16 v[196:197], v9 offset:4096
    ds_read_b64_tr_b16 v[198:199], v9 offset:6144
    ds_read_b64_tr_b16 v[200:201], v10 offset:0
    ds_read_b64_tr_b16 v[202:203], v10 offset:2048
    ds_read_b64_tr_b16 v[204:205], v10 offset:4096
    ds_read_b64_tr_b16 v[206:207], v10 offset:6144
    s_waitcnt lgkmcnt(8)
    v_mfma_f32_16x16x32_bf16 v[88:91], v[184:187], v[120:123], 0
    v_mfma_f32_16x16x32_bf16 v[88:91], v[188:191], v[124:127], v[88:91]
    ds_read_b64_tr_b16 v[208:209], v11 offset:0
    ds_read_b64_tr_b16 v[210:211], v11 offset:2048
    ds_read_b64_tr_b16 v[212:213], v11 offset:4096
    ds_read_b64_tr_b16 v[214:215], v11 offset:6144
    s_waitcnt lgkmcnt(8)
    v_mfma_f32_16x16x32_bf16 v[92:95], v[192:195], v[120:123], 0
    v_mfma_f32_16x16x32_bf16 v[92:95], v[196:199], v[124:127], v[92:95]
    s_waitcnt lgkmcnt(4)
    v_mfma_f32_16x16x32_bf16 v[96:99], v[200:203], v[120:123], 0
    v_mfma_f32_16x16x32_bf16 v[96:99], v[204:207], v[124:127], v[96:99]
    s_waitcnt lgkmcnt(0)
    v_mfma_f32_16x16x32_bf16 v[100:103], v[208:211], v[120:123], 0
    v_mfma_f32_16x16x32_bf16 v[100:103], v[212:215], v[124:127], v[100:103]
    v_add_u32 v5, s46, v5
    v_add_u32 v6, s46, v6
    v_add_u32 v8, s46, v8
    v_add_u32 v9, s46, v9
    v_add_u32 v10, s46, v10
    v_add_u32 v11, s46, v11
    s_nop 1
    v_and_b32 v104, v23, v88
    v_and_b32 v105, v23, v89
    v_and_b32 v106, v23, v90
    v_and_b32 v107, v23, v91
    v_and_b32 v108, v23, v92
    v_and_b32 v109, v23, v93
    v_and_b32 v110, v23, v94
    v_and_b32 v111, v23, v95
    v_and_b32 v112, v23, v96
    v_and_b32 v113, v23, v97
    v_and_b32 v114, v23, v98
    v_and_b32 v115, v23, v99
    v_and_b32 v116, v23, v100
    v_and_b32 v117, v23, v101
    v_and_b32 v118, v23, v102
    v_and_b32 v119, v23, v103
    v_sub_f32 v104, v88, v104
    v_sub_f32 v105, v89, v105
    v_sub_f32 v106, v90, v106
    v_sub_f32 v107, v91, v107
    v_sub_f32 v108, v92, v108
    v_sub_f32 v109, v93, v109
    v_sub_f32 v110, v94, v110
    v_sub_f32 v111, v95, v111
    v_sub_f32 v112, v96, v112
    v_sub_f32 v113, v97, v113
    v_sub_f32 v114, v98, v114
    v_sub_f32 v115, v99, v115
    v_sub_f32 v116, v100, v116
    v_sub_f32 v117, v101, v117
    v_sub_f32 v118, v102, v118
    v_sub_f32 v119, v103, v119
    v_perm_b32 v176, v105, v104, s43
    v_perm_b32 v177, v107, v106, s43
    v_perm_b32 v178, v109, v108, s43
    v_perm_b32 v179, v111, v110, s43
    v_perm_b32 v180, v113, v112, s43
    v_perm_b32 v181, v115, v114, s43
    v_perm_b32 v182, v117, v116, s43
    v_perm_b32 v183, v119, v118, s43
    s_barrier
    ds_read_b64_tr_b16 v[40:41], v5 offset:0
    ds_read_b64_tr_b16 v[42:43], v5 offset:4096
    ds_read_b64_tr_b16 v[44:45], v6 offset:0
    ds_read_b64_tr_b16 v[46:47], v6 offset:4096
    s_waitcnt lgkmcnt(2)
    v_mfma_f32_16x16x32_bf16 v[128:131], v[40:43], v[176:179], v[128:131]
    s_waitcnt lgkmcnt(0)
    v_mfma_f32_16x16x32_bf16 v[132:135], v[44:47], v[176:179], v[132:135]
    s_barrier
    ds_read_b64_tr_b16 v[48:49], v5 offset:8192
    ds_read_b64_tr_b16 v[50:51], v5 offset:12288
    ds_read_b64_tr_b16 v[52:53], v6 offset:8192
    ds_read_b64_tr_b16 v[54:55], v6 offset:12288
    s_waitcnt lgkmcnt(2)
    v_mfma_f32_16x16x32_bf16 v[128:131], v[48:51], v[180:183], v[128:131]
    s_waitcnt lgkmcnt(0)
    v_mfma_f32_16x16x32_bf16 v[132:135], v[52:55], v[180:183], v[132:135]
    s_nop 5
    v_add_f32_dpp v128, v128, v128 row_shl:4 row_mask:0xf bank_mask:0xf
    v_add_f32_dpp v129, v129, v129 row_shl:4 row_mask:0xf bank_mask:0xf
    v_add_f32_dpp v130, v130, v130 row_shl:4 row_mask:0xf bank_mask:0xf
    v_add_f32_dpp v131, v131, v131 row_shl:4 row_mask:0xf bank_mask:0xf
    v_cvt_pk_bf16_f32 v40, v128, v129
    v_cvt_pk_bf16_f32 v41, v130, v131
    buffer_store_dwordx2 v[40:41], v18, s[36:39], 0 offen offset:0
    v_add_f32_dpp v132, v132, v132 row_shl:4 row_mask:0xf bank_mask:0xf
    v_add_f32_dpp v133, v133, v133 row_shl:4 row_mask:0xf bank_mask:0xf
    v_add_f32_dpp v134, v134, v134 row_shl:4 row_mask:0xf bank_mask:0xf
    v_add_f32_dpp v135, v135, v135 row_shl:4 row_mask:0xf bank_mask:0xf
    v_cvt_pk_bf16_f32 v42, v132, v133
    v_cvt_pk_bf16_f32 v43, v134, v135
    buffer_store_dwordx2 v[42:43], v18, s[36:39], 0 offen offset:32
L_done:
    s_endpgm
.section .rodata,"a"
.p2align 6
.amdhsa_kernel standalone__low_rank_proj_linformer__sampling_kernel
  .amdhsa_next_free_vgpr 216
  .amdhsa_next_free_sgpr 56
  .amdhsa_accum_offset 216
  .amdhsa_group_segment_fixed_size 0
  .amdhsa_kernarg_size 64
  .amdhsa_user_sgpr_count 2
  .amdhsa_user_sgpr_kernarg_segment_ptr 1
  .amdhsa_system_sgpr_workgroup_id_x 1
  .amdhsa_float_denorm_mode_32 3
.end_amdhsa_kernel
```
